```python
import torch

def _softmax(x, axis=-1):
    return torch.softmax(x, dim=axis)
def _gelu(x):
    return torch.nn.functional.gelu(x, approximate="tanh")
def _silu(x):
    return torch.nn.functional.silu(x)
def _sigmoid(x):
    return torch.sigmoid(x)
def _layernorm(x, axis=-1, eps=1e-5):
    m = x.mean(dim=axis, keepdim=True)
    v = x.var(dim=axis, keepdim=True, unbiased=False)
    return (x - m) / torch.sqrt(v + eps)
def _scatter_add(tgt, idx, src, axis=0):
    return tgt.clone().index_add_(axis, idx, src)
def _segment_sum(src, seg, n):
    out = torch.zeros((n,) + src.shape[1:], dtype=src.dtype)
    return out.index_add_(0, seg, src)
def _pad(x, pw):
    flat = tuple(v for pair in reversed(pw) for v in pair)
    return torch.nn.functional.pad(x, flat)

kernel_name = 'sequential_preLN__softmax_full_mha__swiglu_ffn__prompt'

def setup_inputs():

    _w = (lambda a: (lambda t: t.to(torch.bfloat16) if t.is_floating_point() else t)(torch.as_tensor(a)))
    def _A_setup():
        B, S, D = 1, 2048, 512
        return {
            "x": _w((lambda *s: torch.randn(*s, dtype=torch.bfloat16) * 0.05)(B, S, D)),
            "wqkv": _w((lambda *s: torch.randn(*s, dtype=torch.bfloat16) * 0.05)(D, 3 * D)),
            "wo": _w((lambda *s: torch.randn(*s, dtype=torch.bfloat16) * 0.05)(D, D)),
        }
    _A_in = _A_setup()

    def _B_setup():
        B, S, D, F = 1, 2048, 512, 1792
        return {
            "x": _w((lambda *s: torch.randn(*s, dtype=torch.bfloat16) * 0.05)(B, S, D)),
            "w_gate": _w((lambda *s: torch.randn(*s, dtype=torch.bfloat16) * 0.05)(D, F)),
            "w_up": _w((lambda *s: torch.randn(*s, dtype=torch.bfloat16) * 0.05)(D, F)),
            "w_down": _w((lambda *s: torch.randn(*s, dtype=torch.bfloat16) * 0.05)(F, D)),
        }
    _B_in = _B_setup()

    return {
        "A_x": _A_in["x"],
        "A_wqkv": _A_in["wqkv"],
        "A_wo": _A_in["wo"],
        "B_x": _B_in["x"],
        "B_w_gate": _B_in["w_gate"],
        "B_w_up": _B_in["w_up"],
        "B_w_down": _B_in["w_down"],
    }

def reference(A_x, A_wqkv, A_wo, B_x, B_w_gate, B_w_up, B_w_down):
    def _A_ref(x, wqkv, wo):
        B, S, D = x.shape
        H = 32; Dh = D // H
        qkv = (lambda x, *d: x.permute(*d))((x @ wqkv).reshape(B, S, 3, H, Dh), 2, 0, 3, 1, 4)
        q, k, v = qkv[0], qkv[1], qkv[2]
        scale = Dh ** -0.5
        scores = torch.einsum("bhqd,bhkd->bhqk", q, k) * scale
        p = _softmax(scores, axis=-1)
        o = torch.einsum("bhqk,bhkd->bhqd", p, v)
        return (lambda x, *d: x.permute(*d))(o, 0, 2, 1, 3).reshape(B, S, D) @ wo

    def _B_ref(x, w_gate, w_up, w_down):
        g = _silu(x @ w_gate)
        u = x @ w_up
        return (g * u) @ w_down

    x = A_x
    h = x + _A_ref(_layernorm(x, axis=-1), A_wqkv, A_wo)
    h2 = h + _B_ref(_layernorm(h, axis=-1), B_w_gate, B_w_up, B_w_down)
    return h2
```

```asm
; @launch grid=(256,1,1) block=(512,1,1) lds=163840
.amdgcn_target "amdgcn-amd-amdhsa--gfx950"

.text
.globl sequential_preLN__softmax_full_mha__swiglu_ffn__prompt_kernel
.p2align 8
.type sequential_preLN__softmax_full_mha__swiglu_ffn__prompt_kernel,@function
sequential_preLN__softmax_full_mha__swiglu_ffn__prompt_kernel:
    s_load_dwordx4 s[4:7], s[0:1], 0
    s_load_dwordx4 s[64:67], s[0:1], 64
    s_cmp_ge_u32 s2, 256
    s_cbranch_scc1 L_end
    s_getpc_b64 s[46:47]
L_pc:
    v_lshlrev_b32 v2, 6, v0
    v_min_u32 v3, L_codeend-L_pc, v2
    global_load_dword v168, v3, s[46:47]
    v_add_u32 v2, 32768, v2
    v_min_u32 v3, L_codeend-L_pc, v2
    global_load_dword v168, v3, s[46:47]
    v_and_b32 v1, 63, v0
    v_lshrrev_b32 v2, 6, v0
    s_nop 0
    v_readfirstlane_b32 s25, v2
    s_and_b32 s27, s2, 6
    s_lshl_b32 s27, s27, 2
    s_lshr_b32 s28, s2, 3
    s_and_b32 s41, s28, 7
    s_add_u32 s27, s27, s41
    s_and_b32 s28, s2, 1
    s_lshl_b32 s28, s28, 2
    s_lshr_b32 s29, s2, 6
    s_add_u32 s28, s28, s29
    s_and_b32 s26, s25, 3
    s_getreg_b32 s30, hwreg(HW_REG_XCC_ID)
    s_and_b32 s30, s30, 7
    s_mul_i32 s31, s30, s30
    s_lshl_b32 s31, s31, 16
    s_lshl_b32 s30, s30, 8
    s_add_u32 s30, s30, s31
    s_add_u32 s51, s30, 1
    s_cmp_lt_u32 s25, 4
    s_cbranch_scc1 L_p1_M
    s_lshl_b32 s29, s29, 1
    s_add_u32 s41, s41, s29
    s_and_b32 s41, s41, 7
    v_lshrrev_b32 v8, 3, v1
    v_and_b32 v9, 7, v1
    s_lshl_b32 s30, s27, 16
    s_lshl_b32 s31, s26, 14
    s_add_u32 s30, s30, s31
    v_lshrrev_b32 v5, 1, v8
    v_xor_b32 v5, v5, v9
    v_lshlrev_b32 v5, 4, v5
    v_lshl_add_u32 v5, v8, 10, v5
    v_add_u32 v10, s30, v5
    v_xor_b32 v5, 64, v5
    v_add_u32 v5, 8192, v5
    v_add_u32 v11, s30, v5
    s_lshl_b32 s34, s26, 11
    s_mul_i32 s31, s26, 49152
    s_lshl_b32 s32, s28, 7
    s_add_u32 s31, s31, s32
    v_bfe_u32 v4, v1, 4, 1
    v_lshlrev_b32 v4, 2, v4
    v_xor_b32 v4, v4, v9
    v_lshlrev_b32 v4, 4, v4
    v_mul_u32_u24 v5, 3072, v8
    v_add3_u32 v12, v4, v5, s31
    s_add_u32 s35, s34, 8192
    s_waitcnt lgkmcnt(0)
    s_mov_b32 s8, s66
    s_mov_b32 s9, s67
    s_mov_b32 s52, s4
    s_mov_b32 s53, s5
    s_mov_b32 s54, 0x200000
    s_mov_b32 s55, 0x20000
    s_mov_b32 s16, s6
    s_mov_b32 s17, s7
    s_mov_b32 s18, 0x180000
    s_mov_b32 s19, 0x20000
    s_add_u32 s36, s41, 0
    s_and_b32 s36, s36, 7
    s_mul_i32 s37, s36, 196608
    s_lshl_b32 s36, s36, 7
    s_add_u32 m0, s34, 0
    s_nop 0
    buffer_load_dwordx4 v10, s[52:55], s36 offen lds
    s_add_u32 m0, s34, 1024
    s_nop 0
    buffer_load_dwordx4 v11, s[52:55], s36 offen lds
    s_add_u32 s38, s37, 0
    s_add_u32 m0, s35, 0
    s_nop 0
    buffer_load_dwordx4 v12, s[16:19], s38 offen lds
    s_add_u32 s38, s37, 24576
    s_add_u32 m0, s35, 1024
    s_nop 0
    buffer_load_dwordx4 v12, s[16:19], s38 offen lds
    s_add_u32 s38, s37, 1024
    s_add_u32 m0, s35, 8192
    s_nop 0
    buffer_load_dwordx4 v12, s[16:19], s38 offen lds
    s_add_u32 s38, s37, 25600
    s_add_u32 m0, s35, 9216
    s_nop 0
    buffer_load_dwordx4 v12, s[16:19], s38 offen lds
    s_add_u32 s38, s37, 2048
    s_add_u32 m0, s35, 16384
    s_nop 0
    buffer_load_dwordx4 v12, s[16:19], s38 offen lds
    s_add_u32 s38, s37, 26624
    s_add_u32 m0, s35, 17408
    s_nop 0
    buffer_load_dwordx4 v12, s[16:19], s38 offen lds
    s_barrier
    s_add_u32 s36, s41, 1
    s_and_b32 s36, s36, 7
    s_mul_i32 s37, s36, 196608
    s_lshl_b32 s36, s36, 7
    s_add_u32 m0, s34, 32768
    s_nop 0
    buffer_load_dwordx4 v10, s[52:55], s36 offen lds
    s_add_u32 m0, s34, 33792
    s_nop 0
    buffer_load_dwordx4 v11, s[52:55], s36 offen lds
    s_add_u32 s38, s37, 0
    s_add_u32 m0, s35, 32768
    s_nop 0
    buffer_load_dwordx4 v12, s[16:19], s38 offen lds
    s_add_u32 s38, s37, 24576
    s_add_u32 m0, s35, 33792
    s_nop 0
    buffer_load_dwordx4 v12, s[16:19], s38 offen lds
    s_add_u32 s38, s37, 1024
    s_add_u32 m0, s35, 40960
    s_nop 0
    buffer_load_dwordx4 v12, s[16:19], s38 offen lds
    s_add_u32 s38, s37, 25600
    s_add_u32 m0, s35, 41984
    s_nop 0
    buffer_load_dwordx4 v12, s[16:19], s38 offen lds
    s_add_u32 s38, s37, 2048
    s_add_u32 m0, s35, 49152
    s_nop 0
    buffer_load_dwordx4 v12, s[16:19], s38 offen lds
    s_add_u32 s38, s37, 26624
    s_add_u32 m0, s35, 50176
    s_nop 0
    buffer_load_dwordx4 v12, s[16:19], s38 offen lds
    s_load_dwordx2 s[10:11], s[0:1], 16
    s_load_dwordx4 s[12:15], s[0:1], 48
    v_and_b32 v2, 31, v1
    v_lshrrev_b32 v3, 5, v1
    v_lshrrev_b32 v4, 1, v2
    v_and_b32 v4, 7, v4
    v_lshlrev_b32 v5, 7, v2
    s_and_b32 s36, s26, 1
    s_lshl_b32 s36, s36, 12
    v_add_u32 v5, s36, v5
    s_lshr_b32 s39, s26, 1
    s_lshl_b32 s39, s39, 2
    v_add_u32 v6, s39, v3
    s_mov_b32 s43, 0xffff0000
    s_mov_b32 s56, s64
    s_mov_b32 s57, s65
    s_mov_b32 s58, 0x100
    s_mov_b32 s59, 0x20000
    s_mov_b32 s20, s8
    s_mov_b32 s21, s9
    s_mov_b32 s22, 0x10000000
    s_mov_b32 s23, 0x20000
    v_add_u32 v7, 0, v6
    v_xor_b32 v7, v7, v4
    v_lshl_add_u32 v20, v7, 4, v5
    v_add_u32 v24, 65536, v20
    v_add_u32 v7, 2, v6
    v_xor_b32 v7, v7, v4
    v_lshl_add_u32 v21, v7, 4, v5
    v_add_u32 v25, 65536, v21
    v_mov_b32 v164, 0
    v_mov_b32 v165, 0
    v_mov_b32 v166, 0
    v_mov_b32 v167, 0
    s_waitcnt vmcnt(8) lgkmcnt(0)
    s_barrier
    ds_read_b128 v[40:43], v20 offset:0
    ds_read_b128 v[44:47], v21 offset:0
    s_add_u32 s36, s41, 2
    s_and_b32 s36, s36, 7
    s_mul_i32 s37, s36, 196608
    s_lshl_b32 s36, s36, 7
    s_add_u32 m0, s34, 65536
    s_nop 0
    buffer_load_dwordx4 v10, s[52:55], s36 offen lds
    s_add_u32 m0, s34, 66560
    s_nop 0
    buffer_load_dwordx4 v11, s[52:55], s36 offen lds
    s_add_u32 s38, s37, 0
    s_add_u32 m0, s35, 65536
    s_nop 0
    buffer_load_dwordx4 v12, s[16:19], s38 offen lds
    s_add_u32 s38, s37, 24576
    s_add_u32 m0, s35, 66560
    s_nop 0
    buffer_load_dwordx4 v12, s[16:19], s38 offen lds
    s_add_u32 s38, s37, 1024
    s_add_u32 m0, s35, 73728
    s_nop 0
    buffer_load_dwordx4 v12, s[16:19], s38 offen lds
    s_add_u32 s38, s37, 25600
    s_add_u32 m0, s35, 74752
    s_nop 0
    buffer_load_dwordx4 v12, s[16:19], s38 offen lds
    s_add_u32 s38, s37, 2048
    s_add_u32 m0, s35, 81920
    s_nop 0
    buffer_load_dwordx4 v12, s[16:19], s38 offen lds
    s_add_u32 s38, s37, 26624
    s_add_u32 m0, s35, 82944
    s_nop 0
    buffer_load_dwordx4 v12, s[16:19], s38 offen lds
    s_waitcnt vmcnt(8) lgkmcnt(0)
    s_barrier
    ds_read_b128 v[48:51], v20 offset:32768
    ds_read_b128 v[52:55], v21 offset:32768
    s_add_u32 s36, s41, 3
    s_and_b32 s36, s36, 7
    s_mul_i32 s37, s36, 196608
    s_lshl_b32 s36, s36, 7
    s_add_u32 m0, s34, 98304
    s_nop 0
    buffer_load_dwordx4 v10, s[52:55], s36 offen lds
    v_lshlrev_b32 v156, 16, v40
    v_and_b32 v157, s43, v40
    v_add_f32 v164, v164, v156
    v_add_f32 v165, v165, v157
    v_fmac_f32 v166, v156, v156
    v_fmac_f32 v167, v157, v157
    s_add_u32 m0, s34, 99328
    s_nop 0
    buffer_load_dwordx4 v11, s[52:55], s36 offen lds
    v_lshlrev_b32 v158, 16, v41
    v_and_b32 v159, s43, v41
    v_add_f32 v164, v164, v158
    v_add_f32 v165, v165, v159
    v_fmac_f32 v166, v158, v158
    v_fmac_f32 v167, v159, v159
    s_add_u32 s38, s37, 0
    s_add_u32 m0, s35, 98304
    s_nop 0
    buffer_load_dwordx4 v12, s[16:19], s38 offen lds
    v_lshlrev_b32 v160, 16, v42
    v_and_b32 v161, s43, v42
    v_add_f32 v164, v164, v160
    v_add_f32 v165, v165, v161
    v_fmac_f32 v166, v160, v160
    v_fmac_f32 v167, v161, v161
    s_add_u32 s38, s37, 24576
    s_add_u32 m0, s35, 99328
    s_nop 0
    buffer_load_dwordx4 v12, s[16:19], s38 offen lds
    v_lshlrev_b32 v162, 16, v43
    v_and_b32 v163, s43, v43
    v_add_f32 v164, v164, v162
    v_add_f32 v165, v165, v163
    v_fmac_f32 v166, v162, v162
    v_fmac_f32 v167, v163, v163
    s_add_u32 s38, s37, 1024
    s_add_u32 m0, s35, 106496
    s_nop 0
    buffer_load_dwordx4 v12, s[16:19], s38 offen lds
    v_lshlrev_b32 v156, 16, v44
    v_and_b32 v157, s43, v44
    v_add_f32 v164, v164, v156
    v_add_f32 v165, v165, v157
    v_fmac_f32 v166, v156, v156
    v_fmac_f32 v167, v157, v157
    s_add_u32 s38, s37, 25600
    s_add_u32 m0, s35, 107520
    s_nop 0
    buffer_load_dwordx4 v12, s[16:19], s38 offen lds
    v_lshlrev_b32 v158, 16, v45
    v_and_b32 v159, s43, v45
    v_add_f32 v164, v164, v158
    v_add_f32 v165, v165, v159
    v_fmac_f32 v166, v158, v158
    v_fmac_f32 v167, v159, v159
    s_add_u32 s38, s37, 2048
    s_add_u32 m0, s35, 114688
    s_nop 0
    buffer_load_dwordx4 v12, s[16:19], s38 offen lds
    v_lshlrev_b32 v160, 16, v46
    v_and_b32 v161, s43, v46
    v_add_f32 v164, v164, v160
    v_add_f32 v165, v165, v161
    v_fmac_f32 v166, v160, v160
    v_fmac_f32 v167, v161, v161
    s_add_u32 s38, s37, 26624
    s_add_u32 m0, s35, 115712
    s_nop 0
    buffer_load_dwordx4 v12, s[16:19], s38 offen lds
    v_lshlrev_b32 v162, 16, v47
    v_and_b32 v163, s43, v47
    v_add_f32 v164, v164, v162
    v_add_f32 v165, v165, v163
    v_fmac_f32 v166, v162, v162
    v_fmac_f32 v167, v163, v163
    s_waitcnt vmcnt(8) lgkmcnt(0)
    s_barrier
    ds_read_b128 v[40:43], v24 offset:0
    ds_read_b128 v[44:47], v25 offset:0
    s_add_u32 s36, s41, 4
    s_and_b32 s36, s36, 7
    s_mul_i32 s37, s36, 196608
    s_lshl_b32 s36, s36, 7
    s_add_u32 m0, s34, 0
    s_nop 0
    buffer_load_dwordx4 v10, s[52:55], s36 offen lds
    v_lshlrev_b32 v156, 16, v48
    v_and_b32 v157, s43, v48
    v_add_f32 v164, v164, v156
    v_add_f32 v165, v165, v157
    v_fmac_f32 v166, v156, v156
    v_fmac_f32 v167, v157, v157
    s_add_u32 m0, s34, 1024
    s_nop 0
    buffer_load_dwordx4 v11, s[52:55], s36 offen lds
    v_lshlrev_b32 v158, 16, v49
    v_and_b32 v159, s43, v49
    v_add_f32 v164, v164, v158
    v_add_f32 v165, v165, v159
    v_fmac_f32 v166, v158, v158
    v_fmac_f32 v167, v159, v159
    s_add_u32 s38, s37, 0
    s_add_u32 m0, s35, 0
    s_nop 0
    buffer_load_dwordx4 v12, s[16:19], s38 offen lds
    v_lshlrev_b32 v160, 16, v50
    v_and_b32 v161, s43, v50
    v_add_f32 v164, v164, v160
    v_add_f32 v165, v165, v161
    v_fmac_f32 v166, v160, v160
    v_fmac_f32 v167, v161, v161
    s_add_u32 s38, s37, 24576
    s_add_u32 m0, s35, 1024
    s_nop 0
    buffer_load_dwordx4 v12, s[16:19], s38 offen lds
    v_lshlrev_b32 v162, 16, v51
    v_and_b32 v163, s43, v51
    v_add_f32 v164, v164, v162
    v_add_f32 v165, v165, v163
    v_fmac_f32 v166, v162, v162
    v_fmac_f32 v167, v163, v163
    s_add_u32 s38, s37, 1024
    s_add_u32 m0, s35, 8192
    s_nop 0
    buffer_load_dwordx4 v12, s[16:19], s38 offen lds
    v_lshlrev_b32 v156, 16, v52
    v_and_b32 v157, s43, v52
    v_add_f32 v164, v164, v156
    v_add_f32 v165, v165, v157
    v_fmac_f32 v166, v156, v156
    v_fmac_f32 v167, v157, v157
    s_add_u32 s38, s37, 25600
    s_add_u32 m0, s35, 9216
    s_nop 0
    buffer_load_dwordx4 v12, s[16:19], s38 offen lds
    v_lshlrev_b32 v158, 16, v53
    v_and_b32 v159, s43, v53
    v_add_f32 v164, v164, v158
    v_add_f32 v165, v165, v159
    v_fmac_f32 v166, v158, v158
    v_fmac_f32 v167, v159, v159
    s_add_u32 s38, s37, 2048
    s_add_u32 m0, s35, 16384
    s_nop 0
    buffer_load_dwordx4 v12, s[16:19], s38 offen lds
    v_lshlrev_b32 v160, 16, v54
    v_and_b32 v161, s43, v54
    v_add_f32 v164, v164, v160
    v_add_f32 v165, v165, v161
    v_fmac_f32 v166, v160, v160
    v_fmac_f32 v167, v161, v161
    s_add_u32 s38, s37, 26624
    s_add_u32 m0, s35, 17408
    s_nop 0
    buffer_load_dwordx4 v12, s[16:19], s38 offen lds
    v_lshlrev_b32 v162, 16, v55
    v_and_b32 v163, s43, v55
    v_add_f32 v164, v164, v162
    v_add_f32 v165, v165, v163
    v_fmac_f32 v166, v162, v162
    v_fmac_f32 v167, v163, v163
    s_waitcnt vmcnt(8) lgkmcnt(0)
    s_barrier
    ds_read_b128 v[48:51], v24 offset:32768
    ds_read_b128 v[52:55], v25 offset:32768
    s_add_u32 s36, s41, 5
    s_and_b32 s36, s36, 7
    s_mul_i32 s37, s36, 196608
    s_lshl_b32 s36, s36, 7
    s_add_u32 m0, s34, 32768
    s_nop 0
    buffer_load_dwordx4 v10, s[52:55], s36 offen lds
    v_lshlrev_b32 v156, 16, v40
    v_and_b32 v157, s43, v40
    v_add_f32 v164, v164, v156
    v_add_f32 v165, v165, v157
    v_fmac_f32 v166, v156, v156
    v_fmac_f32 v167, v157, v157
    s_add_u32 m0, s34, 33792
    s_nop 0
    buffer_load_dwordx4 v11, s[52:55], s36 offen lds
    v_lshlrev_b32 v158, 16, v41
    v_and_b32 v159, s43, v41
    v_add_f32 v164, v164, v158
    v_add_f32 v165, v165, v159
    v_fmac_f32 v166, v158, v158
    v_fmac_f32 v167, v159, v159
    s_add_u32 s38, s37, 0
    s_add_u32 m0, s35, 32768
    s_nop 0
    buffer_load_dwordx4 v12, s[16:19], s38 offen lds
    v_lshlrev_b32 v160, 16, v42
    v_and_b32 v161, s43, v42
    v_add_f32 v164, v164, v160
    v_add_f32 v165, v165, v161
    v_fmac_f32 v166, v160, v160
    v_fmac_f32 v167, v161, v161
    s_add_u32 s38, s37, 24576
    s_add_u32 m0, s35, 33792
    s_nop 0
    buffer_load_dwordx4 v12, s[16:19], s38 offen lds
    v_lshlrev_b32 v162, 16, v43
    v_and_b32 v163, s43, v43
    v_add_f32 v164, v164, v162
    v_add_f32 v165, v165, v163
    v_fmac_f32 v166, v162, v162
    v_fmac_f32 v167, v163, v163
    s_add_u32 s38, s37, 1024
    s_add_u32 m0, s35, 40960
    s_nop 0
    buffer_load_dwordx4 v12, s[16:19], s38 offen lds
    v_lshlrev_b32 v156, 16, v44
    v_and_b32 v157, s43, v44
    v_add_f32 v164, v164, v156
    v_add_f32 v165, v165, v157
    v_fmac_f32 v166, v156, v156
    v_fmac_f32 v167, v157, v157
    s_add_u32 s38, s37, 25600
    s_add_u32 m0, s35, 41984
    s_nop 0
    buffer_load_dwordx4 v12, s[16:19], s38 offen lds
    v_lshlrev_b32 v158, 16, v45
    v_and_b32 v159, s43, v45
    v_add_f32 v164, v164, v158
    v_add_f32 v165, v165, v159
    v_fmac_f32 v166, v158, v158
    v_fmac_f32 v167, v159, v159
    s_add_u32 s38, s37, 2048
    s_add_u32 m0, s35, 49152
    s_nop 0
    buffer_load_dwordx4 v12, s[16:19], s38 offen lds
    v_lshlrev_b32 v160, 16, v46
    v_and_b32 v161, s43, v46
    v_add_f32 v164, v164, v160
    v_add_f32 v165, v165, v161
    v_fmac_f32 v166, v160, v160
    v_fmac_f32 v167, v161, v161
    s_add_u32 s38, s37, 26624
    s_add_u32 m0, s35, 50176
    s_nop 0
    buffer_load_dwordx4 v12, s[16:19], s38 offen lds
    v_lshlrev_b32 v162, 16, v47
    v_and_b32 v163, s43, v47
    v_add_f32 v164, v164, v162
    v_add_f32 v165, v165, v163
    v_fmac_f32 v166, v162, v162
    v_fmac_f32 v167, v163, v163
    s_waitcnt vmcnt(8) lgkmcnt(0)
    s_barrier
    ds_read_b128 v[40:43], v20 offset:0
    ds_read_b128 v[44:47], v21 offset:0
    s_add_u32 s36, s41, 6
    s_and_b32 s36, s36, 7
    s_mul_i32 s37, s36, 196608
    s_lshl_b32 s36, s36, 7
    s_add_u32 m0, s34, 65536
    s_nop 0
    buffer_load_dwordx4 v10, s[52:55], s36 offen lds
    v_lshlrev_b32 v156, 16, v48
    v_and_b32 v157, s43, v48
    v_add_f32 v164, v164, v156
    v_add_f32 v165, v165, v157
    v_fmac_f32 v166, v156, v156
    v_fmac_f32 v167, v157, v157
    s_add_u32 m0, s34, 66560
    s_nop 0
    buffer_load_dwordx4 v11, s[52:55], s36 offen lds
    v_lshlrev_b32 v158, 16, v49
    v_and_b32 v159, s43, v49
    v_add_f32 v164, v164, v158
    v_add_f32 v165, v165, v159
    v_fmac_f32 v166, v158, v158
    v_fmac_f32 v167, v159, v159
    s_add_u32 s38, s37, 0
    s_add_u32 m0, s35, 65536
    s_nop 0
    buffer_load_dwordx4 v12, s[16:19], s38 offen lds
    v_lshlrev_b32 v160, 16, v50
    v_and_b32 v161, s43, v50
    v_add_f32 v164, v164, v160
    v_add_f32 v165, v165, v161
    v_fmac_f32 v166, v160, v160
    v_fmac_f32 v167, v161, v161
    s_add_u32 s38, s37, 24576
    s_add_u32 m0, s35, 66560
    s_nop 0
    buffer_load_dwordx4 v12, s[16:19], s38 offen lds
    v_lshlrev_b32 v162, 16, v51
    v_and_b32 v163, s43, v51
    v_add_f32 v164, v164, v162
    v_add_f32 v165, v165, v163
    v_fmac_f32 v166, v162, v162
    v_fmac_f32 v167, v163, v163
    s_add_u32 s38, s37, 1024
    s_add_u32 m0, s35, 73728
    s_nop 0
    buffer_load_dwordx4 v12, s[16:19], s38 offen lds
    v_lshlrev_b32 v156, 16, v52
    v_and_b32 v157, s43, v52
    v_add_f32 v164, v164, v156
    v_add_f32 v165, v165, v157
    v_fmac_f32 v166, v156, v156
    v_fmac_f32 v167, v157, v157
    s_add_u32 s38, s37, 25600
    s_add_u32 m0, s35, 74752
    s_nop 0
    buffer_load_dwordx4 v12, s[16:19], s38 offen lds
    v_lshlrev_b32 v158, 16, v53
    v_and_b32 v159, s43, v53
    v_add_f32 v164, v164, v158
    v_add_f32 v165, v165, v159
    v_fmac_f32 v166, v158, v158
    v_fmac_f32 v167, v159, v159
    s_add_u32 s38, s37, 2048
    s_add_u32 m0, s35, 81920
    s_nop 0
    buffer_load_dwordx4 v12, s[16:19], s38 offen lds
    v_lshlrev_b32 v160, 16, v54
    v_and_b32 v161, s43, v54
    v_add_f32 v164, v164, v160
    v_add_f32 v165, v165, v161
    v_fmac_f32 v166, v160, v160
    v_fmac_f32 v167, v161, v161
    s_add_u32 s38, s37, 26624
    s_add_u32 m0, s35, 82944
    s_nop 0
    buffer_load_dwordx4 v12, s[16:19], s38 offen lds
    v_lshlrev_b32 v162, 16, v55
    v_and_b32 v163, s43, v55
    v_add_f32 v164, v164, v162
    v_add_f32 v165, v165, v163
    v_fmac_f32 v166, v162, v162
    v_fmac_f32 v167, v163, v163
    s_waitcnt vmcnt(8) lgkmcnt(0)
    s_barrier
    ds_read_b128 v[48:51], v20 offset:32768
    ds_read_b128 v[52:55], v21 offset:32768
    s_add_u32 s36, s41, 7
    s_and_b32 s36, s36, 7
    s_mul_i32 s37, s36, 196608
    s_lshl_b32 s36, s36, 7
    s_add_u32 m0, s34, 98304
    s_nop 0
    buffer_load_dwordx4 v10, s[52:55], s36 offen lds
    v_lshlrev_b32 v156, 16, v40
    v_and_b32 v157, s43, v40
    v_add_f32 v164, v164, v156
    v_add_f32 v165, v165, v157
    v_fmac_f32 v166, v156, v156
    v_fmac_f32 v167, v157, v157
    s_add_u32 m0, s34, 99328
    s_nop 0
    buffer_load_dwordx4 v11, s[52:55], s36 offen lds
    v_lshlrev_b32 v158, 16, v41
    v_and_b32 v159, s43, v41
    v_add_f32 v164, v164, v158
    v_add_f32 v165, v165, v159
    v_fmac_f32 v166, v158, v158
    v_fmac_f32 v167, v159, v159
    s_add_u32 s38, s37, 0
    s_add_u32 m0, s35, 98304
    s_nop 0
    buffer_load_dwordx4 v12, s[16:19], s38 offen lds
    v_lshlrev_b32 v160, 16, v42
    v_and_b32 v161, s43, v42
    v_add_f32 v164, v164, v160
    v_add_f32 v165, v165, v161
    v_fmac_f32 v166, v160, v160
    v_fmac_f32 v167, v161, v161
    s_add_u32 s38, s37, 24576
    s_add_u32 m0, s35, 99328
    s_nop 0
    buffer_load_dwordx4 v12, s[16:19], s38 offen lds
    v_lshlrev_b32 v162, 16, v43
    v_and_b32 v163, s43, v43
    v_add_f32 v164, v164, v162
    v_add_f32 v165, v165, v163
    v_fmac_f32 v166, v162, v162
    v_fmac_f32 v167, v163, v163
    s_add_u32 s38, s37, 1024
    s_add_u32 m0, s35, 106496
    s_nop 0
    buffer_load_dwordx4 v12, s[16:19], s38 offen lds
    v_lshlrev_b32 v156, 16, v44
    v_and_b32 v157, s43, v44
    v_add_f32 v164, v164, v156
    v_add_f32 v165, v165, v157
    v_fmac_f32 v166, v156, v156
    v_fmac_f32 v167, v157, v157
    s_add_u32 s38, s37, 25600
    s_add_u32 m0, s35, 107520
    s_nop 0
    buffer_load_dwordx4 v12, s[16:19], s38 offen lds
    v_lshlrev_b32 v158, 16, v45
    v_and_b32 v159, s43, v45
    v_add_f32 v164, v164, v158
    v_add_f32 v165, v165, v159
    v_fmac_f32 v166, v158, v158
    v_fmac_f32 v167, v159, v159
    s_add_u32 s38, s37, 2048
    s_add_u32 m0, s35, 114688
    s_nop 0
    buffer_load_dwordx4 v12, s[16:19], s38 offen lds
    v_lshlrev_b32 v160, 16, v46
    v_and_b32 v161, s43, v46
    v_add_f32 v164, v164, v160
    v_add_f32 v165, v165, v161
    v_fmac_f32 v166, v160, v160
    v_fmac_f32 v167, v161, v161
    s_add_u32 s38, s37, 26624
    s_add_u32 m0, s35, 115712
    s_nop 0
    buffer_load_dwordx4 v12, s[16:19], s38 offen lds
    v_lshlrev_b32 v162, 16, v47
    v_and_b32 v163, s43, v47
    v_add_f32 v164, v164, v162
    v_add_f32 v165, v165, v163
    v_fmac_f32 v166, v162, v162
    v_fmac_f32 v167, v163, v163
    s_and_b32 s36, s2, 7
    s_lshl_b32 s36, s36, 5
    v_mov_b32 v170, s36
    v_cmp_eq_u32 vcc, 1, v1
    v_mov_b32 v171, 16
    s_nop 0
    v_cndmask_b32 v170, v170, v171, vcc
    buffer_load_dword v171, v170, s[56:59], 0 offen sc1
    s_waitcnt vmcnt(9) lgkmcnt(0)
    s_barrier
    ds_read_b128 v[40:43], v24 offset:0
    ds_read_b128 v[44:47], v25 offset:0
    v_lshlrev_b32 v156, 16, v48
    v_and_b32 v157, s43, v48
    v_add_f32 v164, v164, v156
    v_add_f32 v165, v165, v157
    v_fmac_f32 v166, v156, v156
    v_fmac_f32 v167, v157, v157
    v_lshlrev_b32 v158, 16, v49
    v_and_b32 v159, s43, v49
    v_add_f32 v164, v164, v158
    v_add_f32 v165, v165, v159
    v_fmac_f32 v166, v158, v158
    v_fmac_f32 v167, v159, v159
    v_lshlrev_b32 v160, 16, v50
    v_and_b32 v161, s43, v50
    v_add_f32 v164, v164, v160
    v_add_f32 v165, v165, v161
    v_fmac_f32 v166, v160, v160
    v_fmac_f32 v167, v161, v161
    v_lshlrev_b32 v162, 16, v51
    v_and_b32 v163, s43, v51
    v_add_f32 v164, v164, v162
    v_add_f32 v165, v165, v163
    v_fmac_f32 v166, v162, v162
    v_fmac_f32 v167, v163, v163
    v_lshlrev_b32 v156, 16, v52
    v_and_b32 v157, s43, v52
    v_add_f32 v164, v164, v156
    v_add_f32 v165, v165, v157
    v_fmac_f32 v166, v156, v156
    v_fmac_f32 v167, v157, v157
    v_lshlrev_b32 v158, 16, v53
    v_and_b32 v159, s43, v53
    v_add_f32 v164, v164, v158
    v_add_f32 v165, v165, v159
    v_fmac_f32 v166, v158, v158
    v_fmac_f32 v167, v159, v159
    v_lshlrev_b32 v160, 16, v54
    v_and_b32 v161, s43, v54
    v_add_f32 v164, v164, v160
    v_add_f32 v165, v165, v161
    v_fmac_f32 v166, v160, v160
    v_fmac_f32 v167, v161, v161
    v_lshlrev_b32 v162, 16, v55
    v_and_b32 v163, s43, v55
    v_add_f32 v164, v164, v162
    v_add_f32 v165, v165, v163
    v_fmac_f32 v166, v162, v162
    v_fmac_f32 v167, v163, v163
    s_waitcnt vmcnt(0) lgkmcnt(0)
    s_barrier
    ds_read_b128 v[48:51], v24 offset:32768
    ds_read_b128 v[52:55], v25 offset:32768
    v_lshlrev_b32 v156, 16, v40
    v_and_b32 v157, s43, v40
    v_add_f32 v164, v164, v156
    v_add_f32 v165, v165, v157
    v_fmac_f32 v166, v156, v156
    v_fmac_f32 v167, v157, v157
    v_lshlrev_b32 v158, 16, v41
    v_and_b32 v159, s43, v41
    v_add_f32 v164, v164, v158
    v_add_f32 v165, v165, v159
    v_fmac_f32 v166, v158, v158
    v_fmac_f32 v167, v159, v159
    v_lshlrev_b32 v160, 16, v42
    v_and_b32 v161, s43, v42
    v_add_f32 v164, v164, v160
    v_add_f32 v165, v165, v161
    v_fmac_f32 v166, v160, v160
    v_fmac_f32 v167, v161, v161
    v_lshlrev_b32 v162, 16, v43
    v_and_b32 v163, s43, v43
    v_add_f32 v164, v164, v162
    v_add_f32 v165, v165, v163
    v_fmac_f32 v166, v162, v162
    v_fmac_f32 v167, v163, v163
    v_lshlrev_b32 v156, 16, v44
    v_and_b32 v157, s43, v44
    v_add_f32 v164, v164, v156
    v_add_f32 v165, v165, v157
    v_fmac_f32 v166, v156, v156
    v_fmac_f32 v167, v157, v157
    v_lshlrev_b32 v158, 16, v45
    v_and_b32 v159, s43, v45
    v_add_f32 v164, v164, v158
    v_add_f32 v165, v165, v159
    v_fmac_f32 v166, v158, v158
    v_fmac_f32 v167, v159, v159
    v_lshlrev_b32 v160, 16, v46
    v_and_b32 v161, s43, v46
    v_add_f32 v164, v164, v160
    v_add_f32 v165, v165, v161
    v_fmac_f32 v166, v160, v160
    v_fmac_f32 v167, v161, v161
    v_lshlrev_b32 v162, 16, v47
    v_and_b32 v163, s43, v47
    v_add_f32 v164, v164, v162
    v_add_f32 v165, v165, v163
    v_fmac_f32 v166, v162, v162
    v_fmac_f32 v167, v163, v163
    s_waitcnt lgkmcnt(0)
    v_lshlrev_b32 v156, 16, v48
    v_and_b32 v157, s43, v48
    v_add_f32 v164, v164, v156
    v_add_f32 v165, v165, v157
    v_fmac_f32 v166, v156, v156
    v_fmac_f32 v167, v157, v157
    v_lshlrev_b32 v158, 16, v49
    v_and_b32 v159, s43, v49
    v_add_f32 v164, v164, v158
    v_add_f32 v165, v165, v159
    v_fmac_f32 v166, v158, v158
    v_fmac_f32 v167, v159, v159
    v_lshlrev_b32 v160, 16, v50
    v_and_b32 v161, s43, v50
    v_add_f32 v164, v164, v160
    v_add_f32 v165, v165, v161
    v_fmac_f32 v166, v160, v160
    v_fmac_f32 v167, v161, v161
    v_lshlrev_b32 v162, 16, v51
    v_and_b32 v163, s43, v51
    v_add_f32 v164, v164, v162
    v_add_f32 v165, v165, v163
    v_fmac_f32 v166, v162, v162
    v_fmac_f32 v167, v163, v163
    v_lshlrev_b32 v156, 16, v52
    v_and_b32 v157, s43, v52
    v_add_f32 v164, v164, v156
    v_add_f32 v165, v165, v157
    v_fmac_f32 v166, v156, v156
    v_fmac_f32 v167, v157, v157
    v_lshlrev_b32 v158, 16, v53
    v_and_b32 v159, s43, v53
    v_add_f32 v164, v164, v158
    v_add_f32 v165, v165, v159
    v_fmac_f32 v166, v158, v158
    v_fmac_f32 v167, v159, v159
    v_lshlrev_b32 v160, 16, v54
    v_and_b32 v161, s43, v54
    v_add_f32 v164, v164, v160
    v_add_f32 v165, v165, v161
    v_fmac_f32 v166, v160, v160
    v_fmac_f32 v167, v161, v161
    v_lshlrev_b32 v162, 16, v55
    v_and_b32 v163, s43, v55
    v_add_f32 v164, v164, v162
    v_add_f32 v165, v165, v163
    v_fmac_f32 v166, v162, v162
    v_fmac_f32 v167, v163, v163
    s_mov_b32 s47, 0
L_t_chk:
    v_readlane_b32 s36, v171, 0
    v_readlane_b32 s37, v171, 1
    s_and_b32 s38, s36, 255
    s_cmp_gt_u32 s47, 262144
    s_cbranch_scc1 L_t_ok
    s_cmp_lt_u32 s38, 32
    s_cbranch_scc1 L_t_again
    s_cmp_ge_u32 s37, 1
    s_cbranch_scc1 L_t_ok
L_t_again:
    buffer_load_dword v171, v170, s[56:59], 0 offen sc1
    s_add_u32 s47, s47, 1
    s_waitcnt vmcnt(0)
    s_branch L_t_chk
L_t_ok:
    s_lshl_b32 s38, s51, 5
    s_cmp_eq_u32 s36, s38
    s_cselect_b32 s24, 1, 0
    v_mov_b32 v170, 132608
    v_mov_b32 v171, s24
    ds_write_b32 v170, v171
    v_add_f32 v164, v164, v165
    v_add_f32 v166, v166, v167
    v_mov_b32 v165, v164
    v_mov_b32 v167, v166
    s_nop 0
    v_permlane32_swap_b32 v164, v165
    v_permlane32_swap_b32 v166, v167
    v_add_f32 v164, v164, v165
    v_add_f32 v166, v166, v167
    s_lshl_b32 s37, s26, 8
    v_lshlrev_b32 v4, 2, v2
    v_add_u32 v6, s37, v4
    v_add_u32 v6, 133120, v6
    ds_write_b32 v6, v164
    ds_write_b32 v6, v166 offset:128
    v_xor_b32 v7, 512, v6
    s_waitcnt lgkmcnt(0)
    s_barrier
    ds_read_b32 v165, v7
    ds_read_b32 v167, v7 offset:128
    v_and_b32 v6, 0xfffffdff, v6
    s_waitcnt lgkmcnt(0)
    v_add_f32 v164, v164, v165
    v_add_f32 v166, v166, v167
    v_mul_f32 v164, 0xbb000000, v164
    v_mul_f32 v166, 0x3b000000, v166
    v_fma_f32 v166, -v164, v164, v166
    v_max_f32 v166, 0, v166
    v_add_f32 v166, 0x3727c5ac, v166
    v_rsq_f32 v165, v166
    ds_write_b32 v6, v164 offset:1024
    ds_write_b32 v6, v165 offset:1152
    s_waitcnt lgkmcnt(0)
    s_barrier
    s_barrier
    s_branch L_p2
L_p1_M:
    s_setprio 1
    s_mov_b64 s[48:49], s[46:47]
    s_and_b32 s30, s26, 1
    s_lshr_b32 s31, s26, 1
    s_lshl_b32 s29, s27, 1
    s_add_u32 s29, s29, s30
    v_and_b32 v2, 31, v1
    v_lshrrev_b32 v3, 5, v1
    v_lshrrev_b32 v4, 1, v2
    v_and_b32 v4, 7, v4
    v_lshlrev_b32 v5, 7, v2
    s_lshl_b32 s34, s30, 12
    v_add_u32 v5, s34, v5
    v_bfe_u32 v6, v1, 2, 2
    v_lshrrev_b32 v7, 1, v6
    v_xor_b32 v7, s31, v7
    v_lshl_add_u32 v6, v3, 3, v6
    v_lshlrev_b32 v6, 7, v6
    v_lshl_add_u32 v6, v7, 6, v6
    v_bfe_u32 v7, v1, 4, 1
    v_lshl_add_u32 v6, v7, 5, v6
    v_and_b32 v7, 3, v1
    v_lshl_add_u32 v6, v7, 3, v6
    v_add_u32 v6, 8192, v6
    s_waitcnt lgkmcnt(0)
    s_mov_b32 s8, s66
    s_mov_b32 s9, s67
    s_load_dwordx2 s[10:11], s[0:1], 16
    s_load_dwordx4 s[12:15], s[0:1], 48
    s_load_dwordx4 s[60:63], s[0:1], 32
    s_mov_b32 s56, s64
    s_mov_b32 s57, s65
    s_mov_b32 s58, 0x100
    s_mov_b32 s59, 0x20000
    s_mov_b32 s20, s8
    s_mov_b32 s21, s9
    s_mov_b32 s22, 0x10000000
    s_mov_b32 s23, 0x20000
    s_cmp_lg_u32 s25, 1
    s_cbranch_scc1 L_t_notk
    s_and_b32 s36, s2, 7
    s_lshl_b32 s36, s36, 5
    v_mov_b32 v7, 0
    v_mov_b32 v8, s51
    s_mov_b64 exec, 1
    buffer_atomic_add v8, v7, s[56:59], s36 offen sc1
    s_mov_b64 exec, -1
L_t_notk:
    s_barrier
    s_add_u32 s36, s2, s25
    s_cmp_lg_u32 s36, 0
    s_cbranch_scc1 L_t_nz
    v_lshrrev_b32 v7, 3, v1
    v_and_b32 v9, 7, v1
    v_lshlrev_b32 v7, 8, v7
    v_lshl_add_u32 v7, v9, 4, v7
    v_mov_b32 v8, 0
    v_mov_b32 v9, 0
    v_mov_b32 v10, 0
    v_mov_b32 v11, 0
    s_mov_b32 s36, 25165824
    buffer_store_dwordx4 v[8:11], v7, s[20:23], s36 offen sc1
    s_mov_b32 s36, 25167872
    buffer_store_dwordx4 v[8:11], v7, s[20:23], s36 offen sc1
    s_mov_b32 s36, 25169920
    buffer_store_dwordx4 v[8:11], v7, s[20:23], s36 offen sc1
    s_mov_b32 s36, 25171968
    buffer_store_dwordx4 v[8:11], v7, s[20:23], s36 offen sc1
    s_mov_b32 s36, 25174016
    buffer_store_dwordx4 v[8:11], v7, s[20:23], s36 offen sc1
    s_mov_b32 s36, 25176064
    buffer_store_dwordx4 v[8:11], v7, s[20:23], s36 offen sc1
    s_mov_b32 s36, 25178112
    buffer_store_dwordx4 v[8:11], v7, s[20:23], s36 offen sc1
    s_mov_b32 s36, 25180160
    buffer_store_dwordx4 v[8:11], v7, s[20:23], s36 offen sc1
    v_mov_b32 v12, 1
    s_waitcnt vmcnt(0)
    s_mov_b64 exec, 1
    buffer_store_dword v12, v8, s[56:59], 0 offen offset:16 sc1
    s_mov_b64 exec, -1
L_t_nz:
    s_add_u32 s36, s30, 0
    s_and_b32 s36, s36, 3
    s_lshl_b32 s37, s36, 1
    s_lshl_b32 s38, s36, 11
    v_add_u32 v7, s37, v3
    v_xor_b32 v7, v7, v4
    v_lshl_add_u32 v20, v7, 4, v5
    v_add_u32 v28, s38, v6
    v_add_u32 v24, 65536, v20
    v_add_u32 v32, 65536, v28
    s_add_u32 s36, s30, 1
    s_and_b32 s36, s36, 3
    s_lshl_b32 s37, s36, 1
    s_lshl_b32 s38, s36, 11
    v_add_u32 v7, s37, v3
    v_xor_b32 v7, v7, v4
    v_lshl_add_u32 v21, v7, 4, v5
    v_add_u32 v29, s38, v6
    v_add_u32 v25, 65536, v21
    v_add_u32 v33, 65536, v29
    s_add_u32 s36, s30, 2
    s_and_b32 s36, s36, 3
    s_lshl_b32 s37, s36, 1
    s_lshl_b32 s38, s36, 11
    v_add_u32 v7, s37, v3
    v_xor_b32 v7, v7, v4
    v_lshl_add_u32 v22, v7, 4, v5
    v_add_u32 v30, s38, v6
    v_add_u32 v26, 65536, v22
    v_add_u32 v34, 65536, v30
    s_add_u32 s36, s30, 3
    s_and_b32 s36, s36, 3
    s_lshl_b32 s37, s36, 1
    s_lshl_b32 s38, s36, 11
    v_add_u32 v7, s37, v3
    v_xor_b32 v7, v7, v4
    v_lshl_add_u32 v23, v7, 4, v5
    v_add_u32 v31, s38, v6
    v_add_u32 v27, 65536, v23
    v_add_u32 v35, 65536, v31
    v_and_b32 v7, 15, v1
    v_bfe_u32 v8, v1, 4, 1
    v_sub_u32 v7, v7, v8
    v_mov_b32 v8, 0x3f803f80
    v_cmp_eq_u32 vcc, 0, v7
    s_nop 1
    v_cndmask_b32 v144, 0, v8, vcc
    v_cndmask_b32 v145, 0, v8, vcc
    v_cndmask_b32 v146, 0, v8, vcc
    v_cndmask_b32 v147, 0, v8, vcc
    v_cmp_eq_u32 vcc, 2, v7
    s_nop 1
    v_cndmask_b32 v148, 0, v8, vcc
    v_cndmask_b32 v149, 0, v8, vcc
    v_cndmask_b32 v150, 0, v8, vcc
    v_cndmask_b32 v151, 0, v8, vcc
    v_cmp_eq_u32 vcc, 4, v7
    s_nop 1
    v_cndmask_b32 v152, 0, v8, vcc
    v_cndmask_b32 v153, 0, v8, vcc
    v_cndmask_b32 v154, 0, v8, vcc
    v_cndmask_b32 v155, 0, v8, vcc
    v_lshlrev_b32 v4, 2, v2
    v_add_u32 v4, 136192, v4
    v_and_b32 v5, 15, v1
    v_lshlrev_b32 v5, 2, v5
    v_lshrrev_b32 v7, 4, v1
    v_lshl_add_u32 v5, v7, 8, v5
    v_add_u32 v5, 136192, v5
    s_lshl_b32 s36, s26, 10
    v_add_u32 v5, s36, v5
    s_lshl_b32 s36, s31, 11
    v_add_u32 v4, s36, v4
    v_lshlrev_b32 v7, 2, v1
    v_add_u32 v7, 136192, v7
    v_add_u32 v7, s36, v7
    s_lshl_b32 s37, s30, 8
    s_add_u32 s37, s37, 134144
    v_lshlrev_b32 v8, 4, v3
    v_add_u32 v10, s37, v8
    v_lshlrev_b32 v9, 2, v2
    v_add_u32 v9, s37, v9
    s_lshl_b32 s37, s26, 8
    s_add_u32 s37, s37, 135168
    v_add_u32 v8, s37, v8
    v_lshlrev_b32 v11, 2, v1
    v_add_u32 v11, s37, v11
    v_mov_b32 v12, 132608
    v_bfe_u32 v13, v1, 4, 1
    v_and_b32 v14, 15, v1
    v_lshlrev_b32 v14, 4, v14
    v_lshl_add_u32 v14, v3, 8, v14
    v_lshl_add_u32 v14, v13, 16, v14
    v_lshlrev_b32 v6, 4, v1
    s_lshl_b32 s38, s28, 18
    s_lshl_b32 s39, s31, 17
    s_add_u32 s38, s38, s39
    s_lshl_b32 s39, s29, 10
    s_add_u32 s38, s38, s39
    s_lshl_b32 s45, s28, 8
    s_lshl_b32 s46, s27, 2
    s_add_u32 s45, s45, s46
    s_add_u32 s45, s45, 25178112
    s_waitcnt lgkmcnt(0)
    s_barrier
    ds_read_b128 v[40:43], v20 offset:0
    ds_read_b64_tr_b16 v[52:53], v28 offset:0
    ds_read_b64_tr_b16 v[54:55], v28 offset:512
    ds_read_b64_tr_b16 v[56:57], v28 offset:8192
    ds_read_b64_tr_b16 v[58:59], v28 offset:8704
    ds_read_b64_tr_b16 v[60:61], v28 offset:16384
    ds_read_b64_tr_b16 v[62:63], v28 offset:16896
    ds_read_b128 v[44:47], v21 offset:0
    ds_read_b64_tr_b16 v[64:65], v29 offset:0
    ds_read_b64_tr_b16 v[66:67], v29 offset:512
    ds_read_b64_tr_b16 v[68:69], v29 offset:8192
    ds_read_b64_tr_b16 v[70:71], v29 offset:8704
    ds_read_b64_tr_b16 v[72:73], v29 offset:16384
    ds_read_b64_tr_b16 v[74:75], v29 offset:16896
    ds_read_b128 v[48:51], v22 offset:0
    s_waitcnt lgkmcnt(12)
    v_mfma_f32_32x32x16_bf16 v[80:95], v[52:55], v[40:43], 0
    v_mfma_f32_16x16x32_bf16 v[128:131], v[144:147], v[52:55], 0
    ds_read_b64_tr_b16 v[52:53], v30 offset:0
    ds_read_b64_tr_b16 v[54:55], v30 offset:512
    s_waitcnt lgkmcnt(12)
    v_mfma_f32_32x32x16_bf16 v[96:111], v[56:59], v[40:43], 0
    v_mfma_f32_16x16x32_bf16 v[128:131], v[148:151], v[56:59], v[128:131]
    ds_read_b64_tr_b16 v[56:57], v30 offset:8192
    ds_read_b64_tr_b16 v[58:59], v30 offset:8704
    s_waitcnt lgkmcnt(12)
    v_mfma_f32_32x32x16_bf16 v[112:127], v[40:43], v[60:63], 0
    v_mfma_f32_16x16x32_bf16 v[128:131], v[152:155], v[60:63], v[128:131]
    ds_read_b64_tr_b16 v[60:61], v30 offset:16384
    ds_read_b64_tr_b16 v[62:63], v30 offset:16896
    ds_read_b128 v[40:43], v23 offset:0
    s_waitcnt lgkmcnt(12)
    v_mfma_f32_32x32x16_bf16 v[80:95], v[64:67], v[44:47], v[80:95]
    ds_read_b64_tr_b16 v[64:65], v31 offset:0
    ds_read_b64_tr_b16 v[66:67], v31 offset:512
    s_waitcnt lgkmcnt(12)
    v_mfma_f32_32x32x16_bf16 v[96:111], v[68:71], v[44:47], v[96:111]
    ds_read_b64_tr_b16 v[68:69], v31 offset:8192
    ds_read_b64_tr_b16 v[70:71], v31 offset:8704
    s_waitcnt lgkmcnt(12)
    v_mfma_f32_32x32x16_bf16 v[112:127], v[44:47], v[72:75], v[112:127]
    ds_read_b64_tr_b16 v[72:73], v31 offset:16384
    ds_read_b64_tr_b16 v[74:75], v31 offset:16896
    s_barrier
    ds_read_b128 v[44:47], v20 offset:32768
    s_waitcnt lgkmcnt(12)
    v_mfma_f32_32x32x16_bf16 v[80:95], v[52:55], v[48:51], v[80:95]
    v_mfma_f32_16x16x32_bf16 v[128:131], v[144:147], v[52:55], v[128:131]
    ds_read_b64_tr_b16 v[52:53], v28 offset:32768
    ds_read_b64_tr_b16 v[54:55], v28 offset:33280
    s_waitcnt lgkmcnt(12)
    v_mfma_f32_32x32x16_bf16 v[96:111], v[56:59], v[48:51], v[96:111]
    v_mfma_f32_16x16x32_bf16 v[128:131], v[148:151], v[56:59], v[128:131]
    ds_read_b64_tr_b16 v[56:57], v28 offset:40960
    ds_read_b64_tr_b16 v[58:59], v28 offset:41472
    s_waitcnt lgkmcnt(12)
    v_mfma_f32_32x32x16_bf16 v[112:127], v[48:51], v[60:63], v[112:127]
    v_mfma_f32_16x16x32_bf16 v[128:131], v[152:155], v[60:63], v[128:131]
    ds_read_b64_tr_b16 v[60:61], v28 offset:49152
    ds_read_b64_tr_b16 v[62:63], v28 offset:49664
    ds_read_b128 v[48:51], v21 offset:32768
    s_waitcnt lgkmcnt(12)
    v_mfma_f32_32x32x16_bf16 v[80:95], v[64:67], v[40:43], v[80:95]
    ds_read_b64_tr_b16 v[64:65], v29 offset:32768
    ds_read_b64_tr_b16 v[66:67], v29 offset:33280
    s_waitcnt lgkmcnt(12)
    v_mfma_f32_32x32x16_bf16 v[96:111], v[68:71], v[40:43], v[96:111]
    ds_read_b64_tr_b16 v[68:69], v29 offset:40960
    ds_read_b64_tr_b16 v[70:71], v29 offset:41472
    s_waitcnt lgkmcnt(12)
    v_mfma_f32_32x32x16_bf16 v[112:127], v[40:43], v[72:75], v[112:127]
    ds_read_b64_tr_b16 v[72:73], v29 offset:49152
    ds_read_b64_tr_b16 v[74:75], v29 offset:49664
    ds_read_b128 v[40:43], v22 offset:32768
    s_waitcnt lgkmcnt(12)
    v_mfma_f32_32x32x16_bf16 v[80:95], v[52:55], v[44:47], v[80:95]
    v_mfma_f32_16x16x32_bf16 v[128:131], v[144:147], v[52:55], v[128:131]
    ds_read_b64_tr_b16 v[52:53], v30 offset:32768
    ds_read_b64_tr_b16 v[54:55], v30 offset:33280
    s_waitcnt lgkmcnt(12)
    v_mfma_f32_32x32x16_bf16 v[96:111], v[56:59], v[44:47], v[96:111]
    v_mfma_f32_16x16x32_bf16 v[128:131], v[148:151], v[56:59], v[128:131]
    ds_read_b64_tr_b16 v[56:57], v30 offset:40960
    ds_read_b64_tr_b16 v[58:59], v30 offset:41472
    s_waitcnt lgkmcnt(12)
    v_mfma_f32_32x32x16_bf16 v[112:127], v[44:47], v[60:63], v[112:127]
    v_mfma_f32_16x16x32_bf16 v[128:131], v[152:155], v[60:63], v[128:131]
    ds_read_b64_tr_b16 v[60:61], v30 offset:49152
    ds_read_b64_tr_b16 v[62:63], v30 offset:49664
    ds_read_b128 v[44:47], v23 offset:32768
    s_waitcnt lgkmcnt(12)
    v_mfma_f32_32x32x16_bf16 v[80:95], v[64:67], v[48:51], v[80:95]
    ds_read_b64_tr_b16 v[64:65], v31 offset:32768
    ds_read_b64_tr_b16 v[66:67], v31 offset:33280
    s_waitcnt lgkmcnt(12)
    v_mfma_f32_32x32x16_bf16 v[96:111], v[68:71], v[48:51], v[96:111]
    ds_read_b64_tr_b16 v[68:69], v31 offset:40960
    ds_read_b64_tr_b16 v[70:71], v31 offset:41472
    s_waitcnt lgkmcnt(12)
    v_mfma_f32_32x32x16_bf16 v[112:127], v[48:51], v[72:75], v[112:127]
    ds_read_b64_tr_b16 v[72:73], v31 offset:49152
    ds_read_b64_tr_b16 v[74:75], v31 offset:49664
    s_barrier
    ds_read_b128 v[48:51], v24 offset:0
    s_waitcnt lgkmcnt(12)
    v_mfma_f32_32x32x16_bf16 v[80:95], v[52:55], v[40:43], v[80:95]
    v_mfma_f32_16x16x32_bf16 v[128:131], v[144:147], v[52:55], v[128:131]
    ds_read_b64_tr_b16 v[52:53], v32 offset:0
    ds_read_b64_tr_b16 v[54:55], v32 offset:512
    s_waitcnt lgkmcnt(12)
    v_mfma_f32_32x32x16_bf16 v[96:111], v[56:59], v[40:43], v[96:111]
    v_mfma_f32_16x16x32_bf16 v[128:131], v[148:151], v[56:59], v[128:131]
    ds_read_b64_tr_b16 v[56:57], v32 offset:8192
    ds_read_b64_tr_b16 v[58:59], v32 offset:8704
    s_waitcnt lgkmcnt(12)
    v_mfma_f32_32x32x16_bf16 v[112:127], v[40:43], v[60:63], v[112:127]
    v_mfma_f32_16x16x32_bf16 v[128:131], v[152:155], v[60:63], v[128:131]
    ds_read_b64_tr_b16 v[60:61], v32 offset:16384
    ds_read_b64_tr_b16 v[62:63], v32 offset:16896
    ds_read_b128 v[40:43], v25 offset:0
    s_waitcnt lgkmcnt(12)
    v_mfma_f32_32x32x16_bf16 v[80:95], v[64:67], v[44:47], v[80:95]
    ds_read_b64_tr_b16 v[64:65], v33 offset:0
    ds_read_b64_tr_b16 v[66:67], v33 offset:512
    s_waitcnt lgkmcnt(12)
    v_mfma_f32_32x32x16_bf16 v[96:111], v[68:71], v[44:47], v[96:111]
    ds_read_b64_tr_b16 v[68:69], v33 offset:8192
    ds_read_b64_tr_b16 v[70:71], v33 offset:8704
    s_waitcnt lgkmcnt(12)
    v_mfma_f32_32x32x16_bf16 v[112:127], v[44:47], v[72:75], v[112:127]
    ds_read_b64_tr_b16 v[72:73], v33 offset:16384
    ds_read_b64_tr_b16 v[74:75], v33 offset:16896
    ds_read_b128 v[44:47], v26 offset:0
    s_waitcnt lgkmcnt(12)
    v_mfma_f32_32x32x16_bf16 v[80:95], v[52:55], v[48:51], v[80:95]
    v_mfma_f32_16x16x32_bf16 v[128:131], v[144:147], v[52:55], v[128:131]
    ds_read_b64_tr_b16 v[52:53], v34 offset:0
    ds_read_b64_tr_b16 v[54:55], v34 offset:512
    s_waitcnt lgkmcnt(12)
    v_mfma_f32_32x32x16_bf16 v[96:111], v[56:59], v[48:51], v[96:111]
    v_mfma_f32_16x16x32_bf16 v[128:131], v[148:151], v[56:59], v[128:131]
    ds_read_b64_tr_b16 v[56:57], v34 offset:8192
    ds_read_b64_tr_b16 v[58:59], v34 offset:8704
    s_waitcnt lgkmcnt(12)
    v_mfma_f32_32x32x16_bf16 v[112:127], v[48:51], v[60:63], v[112:127]
    v_mfma_f32_16x16x32_bf16 v[128:131], v[152:155], v[60:63], v[128:131]
    ds_read_b64_tr_b16 v[60:61], v34 offset:16384
    ds_read_b64_tr_b16 v[62:63], v34 offset:16896
    ds_read_b128 v[48:51], v27 offset:0
    s_waitcnt lgkmcnt(12)
    v_mfma_f32_32x32x16_bf16 v[80:95], v[64:67], v[40:43], v[80:95]
    ds_read_b64_tr_b16 v[64:65], v35 offset:0
    ds_read_b64_tr_b16 v[66:67], v35 offset:512
    s_waitcnt lgkmcnt(12)
    v_mfma_f32_32x32x16_bf16 v[96:111], v[68:71], v[40:43], v[96:111]
    ds_read_b64_tr_b16 v[68:69], v35 offset:8192
    ds_read_b64_tr_b16 v[70:71], v35 offset:8704
    s_waitcnt lgkmcnt(12)
    v_mfma_f32_32x32x16_bf16 v[112:127], v[40:43], v[72:75], v[112:127]
    ds_read_b64_tr_b16 v[72:73], v35 offset:16384
    ds_read_b64_tr_b16 v[74:75], v35 offset:16896
    s_barrier
    ds_read_b128 v[40:43], v24 offset:32768
    s_waitcnt lgkmcnt(12)
    v_mfma_f32_32x32x16_bf16 v[80:95], v[52:55], v[44:47], v[80:95]
    v_mfma_f32_16x16x32_bf16 v[128:131], v[144:147], v[52:55], v[128:131]
    ds_read_b64_tr_b16 v[52:53], v32 offset:32768
    ds_read_b64_tr_b16 v[54:55], v32 offset:33280
    s_waitcnt lgkmcnt(12)
    v_mfma_f32_32x32x16_bf16 v[96:111], v[56:59], v[44:47], v[96:111]
    v_mfma_f32_16x16x32_bf16 v[128:131], v[148:151], v[56:59], v[128:131]
    ds_read_b64_tr_b16 v[56:57], v32 offset:40960
    ds_read_b64_tr_b16 v[58:59], v32 offset:41472
    s_waitcnt lgkmcnt(12)
    v_mfma_f32_32x32x16_bf16 v[112:127], v[44:47], v[60:63], v[112:127]
    v_mfma_f32_16x16x32_bf16 v[128:131], v[152:155], v[60:63], v[128:131]
    ds_read_b64_tr_b16 v[60:61], v32 offset:49152
    ds_read_b64_tr_b16 v[62:63], v32 offset:49664
    ds_read_b128 v[44:47], v25 offset:32768
    s_waitcnt lgkmcnt(12)
    v_mfma_f32_32x32x16_bf16 v[80:95], v[64:67], v[48:51], v[80:95]
    ds_read_b64_tr_b16 v[64:65], v33 offset:32768
    ds_read_b64_tr_b16 v[66:67], v33 offset:33280
    s_waitcnt lgkmcnt(12)
    v_mfma_f32_32x32x16_bf16 v[96:111], v[68:71], v[48:51], v[96:111]
    ds_read_b64_tr_b16 v[68:69], v33 offset:40960
    ds_read_b64_tr_b16 v[70:71], v33 offset:41472
    s_waitcnt lgkmcnt(12)
    v_mfma_f32_32x32x16_bf16 v[112:127], v[48:51], v[72:75], v[112:127]
    ds_read_b64_tr_b16 v[72:73], v33 offset:49152
    ds_read_b64_tr_b16 v[74:75], v33 offset:49664
    ds_read_b128 v[48:51], v26 offset:32768
    s_waitcnt lgkmcnt(12)
    v_mfma_f32_32x32x16_bf16 v[80:95], v[52:55], v[40:43], v[80:95]
    v_mfma_f32_16x16x32_bf16 v[128:131], v[144:147], v[52:55], v[128:131]
    ds_read_b64_tr_b16 v[52:53], v34 offset:32768
    ds_read_b64_tr_b16 v[54:55], v34 offset:33280
    s_waitcnt lgkmcnt(12)
    v_mfma_f32_32x32x16_bf16 v[96:111], v[56:59], v[40:43], v[96:111]
    v_mfma_f32_16x16x32_bf16 v[128:131], v[148:151], v[56:59], v[128:131]
    ds_read_b64_tr_b16 v[56:57], v34 offset:40960
    ds_read_b64_tr_b16 v[58:59], v34 offset:41472
    s_waitcnt lgkmcnt(12)
    v_mfma_f32_32x32x16_bf16 v[112:127], v[40:43], v[60:63], v[112:127]
    v_mfma_f32_16x16x32_bf16 v[128:131], v[152:155], v[60:63], v[128:131]
    ds_read_b64_tr_b16 v[60:61], v34 offset:49152
    ds_read_b64_tr_b16 v[62:63], v34 offset:49664
    ds_read_b128 v[40:43], v27 offset:32768
    s_waitcnt lgkmcnt(12)
    v_mfma_f32_32x32x16_bf16 v[80:95], v[64:67], v[44:47], v[80:95]
    ds_read_b64_tr_b16 v[64:65], v35 offset:32768
    ds_read_b64_tr_b16 v[66:67], v35 offset:33280
    s_waitcnt lgkmcnt(12)
    v_mfma_f32_32x32x16_bf16 v[96:111], v[68:71], v[44:47], v[96:111]
    ds_read_b64_tr_b16 v[68:69], v35 offset:40960
    ds_read_b64_tr_b16 v[70:71], v35 offset:41472
    s_waitcnt lgkmcnt(12)
    v_mfma_f32_32x32x16_bf16 v[112:127], v[44:47], v[72:75], v[112:127]
    ds_read_b64_tr_b16 v[72:73], v35 offset:49152
    ds_read_b64_tr_b16 v[74:75], v35 offset:49664
    s_barrier
    ds_read_b128 v[44:47], v20 offset:0
    s_waitcnt lgkmcnt(12)
    v_mfma_f32_32x32x16_bf16 v[80:95], v[52:55], v[48:51], v[80:95]
    v_mfma_f32_16x16x32_bf16 v[128:131], v[144:147], v[52:55], v[128:131]
    ds_read_b64_tr_b16 v[52:53], v28 offset:0
    ds_read_b64_tr_b16 v[54:55], v28 offset:512
    s_waitcnt lgkmcnt(12)
    v_mfma_f32_32x32x16_bf16 v[96:111], v[56:59], v[48:51], v[96:111]
    v_mfma_f32_16x16x32_bf16 v[128:131], v[148:151], v[56:59], v[128:131]
    ds_read_b64_tr_b16 v[56:57], v28 offset:8192
    ds_read_b64_tr_b16 v[58:59], v28 offset:8704
    s_waitcnt lgkmcnt(12)
    v_mfma_f32_32x32x16_bf16 v[112:127], v[48:51], v[60:63], v[112:127]
    v_mfma_f32_16x16x32_bf16 v[128:131], v[152:155], v[60:63], v[128:131]
    ds_read_b64_tr_b16 v[60:61], v28 offset:16384
    ds_read_b64_tr_b16 v[62:63], v28 offset:16896
    ds_read_b128 v[48:51], v21 offset:0
    s_waitcnt lgkmcnt(12)
    v_mfma_f32_32x32x16_bf16 v[80:95], v[64:67], v[40:43], v[80:95]
    ds_read_b64_tr_b16 v[64:65], v29 offset:0
    ds_read_b64_tr_b16 v[66:67], v29 offset:512
    s_waitcnt lgkmcnt(12)
    v_mfma_f32_32x32x16_bf16 v[96:111], v[68:71], v[40:43], v[96:111]
    ds_read_b64_tr_b16 v[68:69], v29 offset:8192
    ds_read_b64_tr_b16 v[70:71], v29 offset:8704
    s_waitcnt lgkmcnt(12)
    v_mfma_f32_32x32x16_bf16 v[112:127], v[40:43], v[72:75], v[112:127]
    ds_read_b64_tr_b16 v[72:73], v29 offset:16384
    ds_read_b64_tr_b16 v[74:75], v29 offset:16896
    ds_read_b128 v[40:43], v22 offset:0
    s_waitcnt lgkmcnt(12)
    v_mfma_f32_32x32x16_bf16 v[80:95], v[52:55], v[44:47], v[80:95]
    v_mfma_f32_16x16x32_bf16 v[128:131], v[144:147], v[52:55], v[128:131]
    ds_read_b64_tr_b16 v[52:53], v30 offset:0
    ds_read_b64_tr_b16 v[54:55], v30 offset:512
    s_waitcnt lgkmcnt(12)
    v_mfma_f32_32x32x16_bf16 v[96:111], v[56:59], v[44:47], v[96:111]
    v_mfma_f32_16x16x32_bf16 v[128:131], v[148:151], v[56:59], v[128:131]
    ds_read_b64_tr_b16 v[56:57], v30 offset:8192
    ds_read_b64_tr_b16 v[58:59], v30 offset:8704
    s_waitcnt lgkmcnt(12)
    v_mfma_f32_32x32x16_bf16 v[112:127], v[44:47], v[60:63], v[112:127]
    v_mfma_f32_16x16x32_bf16 v[128:131], v[152:155], v[60:63], v[128:131]
    ds_read_b64_tr_b16 v[60:61], v30 offset:16384
    ds_read_b64_tr_b16 v[62:63], v30 offset:16896
    ds_read_b128 v[44:47], v23 offset:0
    s_waitcnt lgkmcnt(12)
    v_mfma_f32_32x32x16_bf16 v[80:95], v[64:67], v[48:51], v[80:95]
    ds_read_b64_tr_b16 v[64:65], v31 offset:0
    ds_read_b64_tr_b16 v[66:67], v31 offset:512
    s_waitcnt lgkmcnt(12)
    v_mfma_f32_32x32x16_bf16 v[96:111], v[68:71], v[48:51], v[96:111]
    ds_read_b64_tr_b16 v[68:69], v31 offset:8192
    ds_read_b64_tr_b16 v[70:71], v31 offset:8704
    s_waitcnt lgkmcnt(12)
    v_mfma_f32_32x32x16_bf16 v[112:127], v[48:51], v[72:75], v[112:127]
    ds_read_b64_tr_b16 v[72:73], v31 offset:16384
    ds_read_b64_tr_b16 v[74:75], v31 offset:16896
    s_barrier
    ds_read_b128 v[48:51], v20 offset:32768
    s_waitcnt lgkmcnt(12)
    v_mfma_f32_32x32x16_bf16 v[80:95], v[52:55], v[40:43], v[80:95]
    v_mfma_f32_16x16x32_bf16 v[128:131], v[144:147], v[52:55], v[128:131]
    ds_read_b64_tr_b16 v[52:53], v28 offset:32768
    ds_read_b64_tr_b16 v[54:55], v28 offset:33280
    s_waitcnt lgkmcnt(12)
    v_mfma_f32_32x32x16_bf16 v[96:111], v[56:59], v[40:43], v[96:111]
    v_mfma_f32_16x16x32_bf16 v[128:131], v[148:151], v[56:59], v[128:131]
    ds_read_b64_tr_b16 v[56:57], v28 offset:40960
    ds_read_b64_tr_b16 v[58:59], v28 offset:41472
    s_waitcnt lgkmcnt(12)
    v_mfma_f32_32x32x16_bf16 v[112:127], v[40:43], v[60:63], v[112:127]
    v_mfma_f32_16x16x32_bf16 v[128:131], v[152:155], v[60:63], v[128:131]
    ds_read_b64_tr_b16 v[60:61], v28 offset:49152
    ds_read_b64_tr_b16 v[62:63], v28 offset:49664
    ds_read_b128 v[40:43], v21 offset:32768
    s_waitcnt lgkmcnt(12)
    v_mfma_f32_32x32x16_bf16 v[80:95], v[64:67], v[44:47], v[80:95]
    ds_read_b64_tr_b16 v[64:65], v29 offset:32768
    ds_read_b64_tr_b16 v[66:67], v29 offset:33280
    s_waitcnt lgkmcnt(12)
    v_mfma_f32_32x32x16_bf16 v[96:111], v[68:71], v[44:47], v[96:111]
    ds_read_b64_tr_b16 v[68:69], v29 offset:40960
    ds_read_b64_tr_b16 v[70:71], v29 offset:41472
    s_waitcnt lgkmcnt(12)
    v_mfma_f32_32x32x16_bf16 v[112:127], v[44:47], v[72:75], v[112:127]
    ds_read_b64_tr_b16 v[72:73], v29 offset:49152
    ds_read_b64_tr_b16 v[74:75], v29 offset:49664
    ds_read_b128 v[44:47], v22 offset:32768
    s_waitcnt lgkmcnt(12)
    v_mfma_f32_32x32x16_bf16 v[80:95], v[52:55], v[48:51], v[80:95]
    v_mfma_f32_16x16x32_bf16 v[128:131], v[144:147], v[52:55], v[128:131]
    ds_read_b64_tr_b16 v[52:53], v30 offset:32768
    ds_read_b64_tr_b16 v[54:55], v30 offset:33280
    s_waitcnt lgkmcnt(12)
    v_mfma_f32_32x32x16_bf16 v[96:111], v[56:59], v[48:51], v[96:111]
    v_mfma_f32_16x16x32_bf16 v[128:131], v[148:151], v[56:59], v[128:131]
    ds_read_b64_tr_b16 v[56:57], v30 offset:40960
    ds_read_b64_tr_b16 v[58:59], v30 offset:41472
    s_waitcnt lgkmcnt(12)
    v_mfma_f32_32x32x16_bf16 v[112:127], v[48:51], v[60:63], v[112:127]
    v_mfma_f32_16x16x32_bf16 v[128:131], v[152:155], v[60:63], v[128:131]
    ds_read_b64_tr_b16 v[60:61], v30 offset:49152
    ds_read_b64_tr_b16 v[62:63], v30 offset:49664
    ds_read_b128 v[48:51], v23 offset:32768
    s_waitcnt lgkmcnt(12)
    v_mfma_f32_32x32x16_bf16 v[80:95], v[64:67], v[40:43], v[80:95]
    ds_read_b64_tr_b16 v[64:65], v31 offset:32768
    ds_read_b64_tr_b16 v[66:67], v31 offset:33280
    s_waitcnt lgkmcnt(12)
    v_mfma_f32_32x32x16_bf16 v[96:111], v[68:71], v[40:43], v[96:111]
    ds_read_b64_tr_b16 v[68:69], v31 offset:40960
    ds_read_b64_tr_b16 v[70:71], v31 offset:41472
    s_waitcnt lgkmcnt(12)
    v_mfma_f32_32x32x16_bf16 v[112:127], v[40:43], v[72:75], v[112:127]
    ds_read_b64_tr_b16 v[72:73], v31 offset:49152
    ds_read_b64_tr_b16 v[74:75], v31 offset:49664
    s_barrier
    ds_read_b128 v[40:43], v24 offset:0
    s_waitcnt lgkmcnt(12)
    v_mfma_f32_32x32x16_bf16 v[80:95], v[52:55], v[44:47], v[80:95]
    v_mfma_f32_16x16x32_bf16 v[128:131], v[144:147], v[52:55], v[128:131]
    ds_read_b64_tr_b16 v[52:53], v32 offset:0
    ds_read_b64_tr_b16 v[54:55], v32 offset:512
    s_waitcnt lgkmcnt(12)
    v_mfma_f32_32x32x16_bf16 v[96:111], v[56:59], v[44:47], v[96:111]
    v_mfma_f32_16x16x32_bf16 v[128:131], v[148:151], v[56:59], v[128:131]
    ds_read_b64_tr_b16 v[56:57], v32 offset:8192
    ds_read_b64_tr_b16 v[58:59], v32 offset:8704
    s_waitcnt lgkmcnt(12)
    v_mfma_f32_32x32x16_bf16 v[112:127], v[44:47], v[60:63], v[112:127]
    v_mfma_f32_16x16x32_bf16 v[128:131], v[152:155], v[60:63], v[128:131]
    ds_read_b64_tr_b16 v[60:61], v32 offset:16384
    ds_read_b64_tr_b16 v[62:63], v32 offset:16896
    ds_read_b128 v[44:47], v25 offset:0
    s_waitcnt lgkmcnt(12)
    v_mfma_f32_32x32x16_bf16 v[80:95], v[64:67], v[48:51], v[80:95]
    ds_read_b64_tr_b16 v[64:65], v33 offset:0
    ds_read_b64_tr_b16 v[66:67], v33 offset:512
    s_waitcnt lgkmcnt(12)
    v_mfma_f32_32x32x16_bf16 v[96:111], v[68:71], v[48:51], v[96:111]
    ds_read_b64_tr_b16 v[68:69], v33 offset:8192
    ds_read_b64_tr_b16 v[70:71], v33 offset:8704
    s_waitcnt lgkmcnt(12)
    v_mfma_f32_32x32x16_bf16 v[112:127], v[48:51], v[72:75], v[112:127]
    ds_read_b64_tr_b16 v[72:73], v33 offset:16384
    ds_read_b64_tr_b16 v[74:75], v33 offset:16896
    ds_read_b128 v[48:51], v26 offset:0
    s_waitcnt lgkmcnt(12)
    v_mfma_f32_32x32x16_bf16 v[80:95], v[52:55], v[40:43], v[80:95]
    v_mfma_f32_16x16x32_bf16 v[128:131], v[144:147], v[52:55], v[128:131]
    ds_read_b64_tr_b16 v[52:53], v34 offset:0
    ds_read_b64_tr_b16 v[54:55], v34 offset:512
    s_waitcnt lgkmcnt(12)
    v_mfma_f32_32x32x16_bf16 v[96:111], v[56:59], v[40:43], v[96:111]
    v_mfma_f32_16x16x32_bf16 v[128:131], v[148:151], v[56:59], v[128:131]
    ds_read_b64_tr_b16 v[56:57], v34 offset:8192
    ds_read_b64_tr_b16 v[58:59], v34 offset:8704
    s_waitcnt lgkmcnt(12)
    v_mfma_f32_32x32x16_bf16 v[112:127], v[40:43], v[60:63], v[112:127]
    v_mfma_f32_16x16x32_bf16 v[128:131], v[152:155], v[60:63], v[128:131]
    ds_read_b64_tr_b16 v[60:61], v34 offset:16384
    ds_read_b64_tr_b16 v[62:63], v34 offset:16896
    ds_read_b128 v[40:43], v27 offset:0
    s_waitcnt lgkmcnt(12)
    v_mfma_f32_32x32x16_bf16 v[80:95], v[64:67], v[44:47], v[80:95]
    ds_read_b64_tr_b16 v[64:65], v35 offset:0
    ds_read_b64_tr_b16 v[66:67], v35 offset:512
    s_waitcnt lgkmcnt(12)
    v_mfma_f32_32x32x16_bf16 v[96:111], v[68:71], v[44:47], v[96:111]
    ds_read_b64_tr_b16 v[68:69], v35 offset:8192
    ds_read_b64_tr_b16 v[70:71], v35 offset:8704
    s_waitcnt lgkmcnt(12)
    v_mfma_f32_32x32x16_bf16 v[112:127], v[44:47], v[72:75], v[112:127]
    ds_read_b64_tr_b16 v[72:73], v35 offset:16384
    ds_read_b64_tr_b16 v[74:75], v35 offset:16896
    s_barrier
    ds_read_b128 v[44:47], v24 offset:32768
    s_waitcnt lgkmcnt(12)
    v_mfma_f32_32x32x16_bf16 v[80:95], v[52:55], v[48:51], v[80:95]
    v_mfma_f32_16x16x32_bf16 v[128:131], v[144:147], v[52:55], v[128:131]
    ds_read_b64_tr_b16 v[52:53], v32 offset:32768
    ds_read_b64_tr_b16 v[54:55], v32 offset:33280
    s_waitcnt lgkmcnt(12)
    v_mfma_f32_32x32x16_bf16 v[96:111], v[56:59], v[48:51], v[96:111]
    v_mfma_f32_16x16x32_bf16 v[128:131], v[148:151], v[56:59], v[128:131]
    ds_read_b64_tr_b16 v[56:57], v32 offset:40960
    ds_read_b64_tr_b16 v[58:59], v32 offset:41472
    s_waitcnt lgkmcnt(12)
    v_mfma_f32_32x32x16_bf16 v[112:127], v[48:51], v[60:63], v[112:127]
    v_mfma_f32_16x16x32_bf16 v[128:131], v[152:155], v[60:63], v[128:131]
    ds_read_b64_tr_b16 v[60:61], v32 offset:49152
    ds_read_b64_tr_b16 v[62:63], v32 offset:49664
    ds_read_b128 v[48:51], v25 offset:32768
    s_waitcnt lgkmcnt(12)
    v_mfma_f32_32x32x16_bf16 v[80:95], v[64:67], v[40:43], v[80:95]
    ds_read_b64_tr_b16 v[64:65], v33 offset:32768
    ds_read_b64_tr_b16 v[66:67], v33 offset:33280
    s_waitcnt lgkmcnt(12)
    v_mfma_f32_32x32x16_bf16 v[96:111], v[68:71], v[40:43], v[96:111]
    ds_read_b64_tr_b16 v[68:69], v33 offset:40960
    ds_read_b64_tr_b16 v[70:71], v33 offset:41472
    s_waitcnt lgkmcnt(12)
    v_mfma_f32_32x32x16_bf16 v[112:127], v[40:43], v[72:75], v[112:127]
    ds_read_b64_tr_b16 v[72:73], v33 offset:49152
    ds_read_b64_tr_b16 v[74:75], v33 offset:49664
    ds_read_b128 v[40:43], v26 offset:32768
    s_waitcnt lgkmcnt(12)
    v_mfma_f32_32x32x16_bf16 v[80:95], v[52:55], v[44:47], v[80:95]
    v_mfma_f32_16x16x32_bf16 v[128:131], v[144:147], v[52:55], v[128:131]
    ds_read_b64_tr_b16 v[52:53], v34 offset:32768
    ds_read_b64_tr_b16 v[54:55], v34 offset:33280
    s_waitcnt lgkmcnt(12)
    v_mfma_f32_32x32x16_bf16 v[96:111], v[56:59], v[44:47], v[96:111]
    v_mfma_f32_16x16x32_bf16 v[128:131], v[148:151], v[56:59], v[128:131]
    ds_read_b64_tr_b16 v[56:57], v34 offset:40960
    ds_read_b64_tr_b16 v[58:59], v34 offset:41472
    s_waitcnt lgkmcnt(12)
    v_mfma_f32_32x32x16_bf16 v[112:127], v[44:47], v[60:63], v[112:127]
    v_mfma_f32_16x16x32_bf16 v[128:131], v[152:155], v[60:63], v[128:131]
    ds_read_b64_tr_b16 v[60:61], v34 offset:49152
    ds_read_b64_tr_b16 v[62:63], v34 offset:49664
    ds_read_b128 v[44:47], v27 offset:32768
    s_waitcnt lgkmcnt(12)
    v_mfma_f32_32x32x16_bf16 v[80:95], v[64:67], v[48:51], v[80:95]
    ds_read_b64_tr_b16 v[64:65], v35 offset:32768
    ds_read_b64_tr_b16 v[66:67], v35 offset:33280
    s_waitcnt lgkmcnt(12)
    v_mfma_f32_32x32x16_bf16 v[96:111], v[68:71], v[48:51], v[96:111]
    ds_read_b64_tr_b16 v[68:69], v35 offset:40960
    ds_read_b64_tr_b16 v[70:71], v35 offset:41472
    s_waitcnt lgkmcnt(12)
    v_mfma_f32_32x32x16_bf16 v[112:127], v[48:51], v[72:75], v[112:127]
    ds_read_b64_tr_b16 v[72:73], v35 offset:49152
    ds_read_b64_tr_b16 v[74:75], v35 offset:49664
    s_barrier
    s_waitcnt lgkmcnt(11)
    v_mfma_f32_32x32x16_bf16 v[80:95], v[52:55], v[40:43], v[80:95]
    v_mfma_f32_16x16x32_bf16 v[128:131], v[144:147], v[52:55], v[128:131]
    s_waitcnt lgkmcnt(9)
    v_mfma_f32_32x32x16_bf16 v[96:111], v[56:59], v[40:43], v[96:111]
    v_mfma_f32_16x16x32_bf16 v[128:131], v[148:151], v[56:59], v[128:131]
    s_waitcnt lgkmcnt(7)
    v_mfma_f32_32x32x16_bf16 v[112:127], v[40:43], v[60:63], v[112:127]
    v_mfma_f32_16x16x32_bf16 v[128:131], v[152:155], v[60:63], v[128:131]
    s_waitcnt lgkmcnt(4)
    v_mfma_f32_32x32x16_bf16 v[80:95], v[64:67], v[44:47], v[80:95]
    s_waitcnt lgkmcnt(2)
    v_mfma_f32_32x32x16_bf16 v[96:111], v[68:71], v[44:47], v[96:111]
    s_waitcnt lgkmcnt(0)
    v_mfma_f32_32x32x16_bf16 v[112:127], v[44:47], v[72:75], v[112:127]
    s_nop 1
    ds_write_b32 v5, v128 offset:0
    ds_write_b32 v5, v129 offset:64
    ds_write_b32 v5, v130 offset:128
    ds_write_b32 v5, v131 offset:192
    s_waitcnt lgkmcnt(0)
    s_barrier
    ds_read_b32 v12, v12
    ds_read_b32 v156, v7 offset:0
    ds_read_b32 v158, v4 offset:256
    ds_read_b32 v157, v7 offset:1024
    ds_read_b32 v159, v4 offset:1280
    ds_read_b128 v[40:43], v10 offset:0
    ds_read_b128 v[56:59], v10 offset:128
    ds_read_b128 v[44:47], v10 offset:32
    ds_read_b128 v[60:63], v10 offset:160
    ds_read_b128 v[48:51], v10 offset:64
    ds_read_b128 v[64:67], v10 offset:192
    ds_read_b128 v[52:55], v10 offset:96
    ds_read_b128 v[68:71], v10 offset:224
    ds_read_b32 v164, v9
    ds_read_b32 v166, v9 offset:128
    s_waitcnt lgkmcnt(10)
    v_readfirstlane_b32 s24, v12
    v_add_f32 v156, v156, v157
    v_add_f32 v172, v158, v159
    v_add_f32 v173, v158, v159
    ds_write_b32 v11, v156
    s_waitcnt lgkmcnt(0)
    ds_read_b128 v[128:131], v8 offset:0
    ds_read_b128 v[132:135], v8 offset:32
    ds_read_b128 v[136:139], v8 offset:64
    ds_read_b128 v[140:143], v8 offset:96
    ds_read_b128 v[144:147], v8 offset:128
    ds_read_b128 v[148:151], v8 offset:160
    ds_read_b128 v[152:155], v8 offset:192
    ds_read_b128 v[156:159], v8 offset:224
    v_pk_fma_f32 v[112:113], v[40:41], v[172:173], v[112:113]
    v_pk_fma_f32 v[114:115], v[42:43], v[172:173], v[114:115]
    v_pk_fma_f32 v[116:117], v[44:45], v[172:173], v[116:117]
    v_pk_fma_f32 v[118:119], v[46:47], v[172:173], v[118:119]
    v_pk_fma_f32 v[120:121], v[48:49], v[172:173], v[120:121]
    v_pk_fma_f32 v[122:123], v[50:51], v[172:173], v[122:123]
    v_pk_fma_f32 v[124:125], v[52:53], v[172:173], v[124:125]
    v_pk_fma_f32 v[126:127], v[54:55], v[172:173], v[126:127]
    v_pk_mul_f32 v[112:113], v[112:113], v[56:57]
    v_pk_mul_f32 v[114:115], v[114:115], v[58:59]
    v_pk_mul_f32 v[116:117], v[116:117], v[60:61]
    v_pk_mul_f32 v[118:119], v[118:119], v[62:63]
    v_pk_mul_f32 v[120:121], v[120:121], v[64:65]
    v_pk_mul_f32 v[122:123], v[122:123], v[66:67]
    v_pk_mul_f32 v[124:125], v[124:125], v[68:69]
    v_pk_mul_f32 v[126:127], v[126:127], v[70:71]
    v_cvt_pk_bf16_f32 v112, v112, v113
    v_cvt_pk_bf16_f32 v113, v114, v115
    v_cvt_pk_bf16_f32 v114, v116, v117
    v_cvt_pk_bf16_f32 v115, v118, v119
    v_cvt_pk_bf16_f32 v116, v120, v121
    v_cvt_pk_bf16_f32 v117, v122, v123
    v_cvt_pk_bf16_f32 v118, v124, v125
    v_cvt_pk_bf16_f32 v119, v126, v127
    s_add_u32 s39, s38, 4194304
    buffer_store_dwordx4 v[112:115], v14, s[20:23], s39 offen sc1
    buffer_store_dwordx4 v[116:119], v14, s[20:23], s39 offen offset:512 sc1
    v_mov_b32 v165, v164
    v_mov_b32 v167, v166
    v_mul_f32 v170, 0x3eb8aa3b, v166
    v_mul_f32 v171, 0x3eb8aa3b, v166
    s_waitcnt lgkmcnt(0)
    v_pk_fma_f32 v[96:97], v[164:165], v[144:145], v[96:97]
    v_pk_fma_f32 v[98:99], v[164:165], v[146:147], v[98:99]
    v_pk_fma_f32 v[100:101], v[164:165], v[148:149], v[100:101]
    v_pk_fma_f32 v[102:103], v[164:165], v[150:151], v[102:103]
    v_pk_fma_f32 v[104:105], v[164:165], v[152:153], v[104:105]
    v_pk_fma_f32 v[106:107], v[164:165], v[154:155], v[106:107]
    v_pk_fma_f32 v[108:109], v[164:165], v[156:157], v[108:109]
    v_pk_fma_f32 v[110:111], v[164:165], v[158:159], v[110:111]
    v_pk_mul_f32 v[96:97], v[96:97], v[166:167]
    v_pk_mul_f32 v[98:99], v[98:99], v[166:167]
    v_pk_mul_f32 v[100:101], v[100:101], v[166:167]
    v_pk_mul_f32 v[102:103], v[102:103], v[166:167]
    v_pk_mul_f32 v[104:105], v[104:105], v[166:167]
    v_pk_mul_f32 v[106:107], v[106:107], v[166:167]
    v_pk_mul_f32 v[108:109], v[108:109], v[166:167]
    v_pk_mul_f32 v[110:111], v[110:111], v[166:167]
    v_cvt_pk_bf16_f32 v96, v96, v97
    v_cvt_pk_bf16_f32 v97, v98, v99
    v_cvt_pk_bf16_f32 v98, v100, v101
    v_cvt_pk_bf16_f32 v99, v102, v103
    v_cvt_pk_bf16_f32 v100, v104, v105
    v_cvt_pk_bf16_f32 v101, v106, v107
    v_cvt_pk_bf16_f32 v102, v108, v109
    v_cvt_pk_bf16_f32 v103, v110, v111
    s_add_u32 s39, s38, 2097152
    s_add_u32 s40, s38, 2162688
    buffer_store_dwordx4 v[96:99], v6, s[20:23], s39 offen sc1
    buffer_store_dwordx4 v[100:103], v6, s[20:23], s40 offen sc1
    v_pk_fma_f32 v[80:81], v[164:165], v[128:129], v[80:81]
    v_pk_fma_f32 v[82:83], v[164:165], v[130:131], v[82:83]
    v_pk_fma_f32 v[84:85], v[164:165], v[132:133], v[84:85]
    v_pk_fma_f32 v[86:87], v[164:165], v[134:135], v[86:87]
    v_pk_fma_f32 v[88:89], v[164:165], v[136:137], v[88:89]
    v_pk_fma_f32 v[90:91], v[164:165], v[138:139], v[90:91]
    v_pk_fma_f32 v[92:93], v[164:165], v[140:141], v[92:93]
    v_pk_fma_f32 v[94:95], v[164:165], v[142:143], v[94:95]
    v_pk_mul_f32 v[80:81], v[80:81], v[170:171]
    v_pk_mul_f32 v[82:83], v[82:83], v[170:171]
    v_pk_mul_f32 v[84:85], v[84:85], v[170:171]
    v_pk_mul_f32 v[86:87], v[86:87], v[170:171]
    v_pk_mul_f32 v[88:89], v[88:89], v[170:171]
    v_pk_mul_f32 v[90:91], v[90:91], v[170:171]
    v_pk_mul_f32 v[92:93], v[92:93], v[170:171]
    v_pk_mul_f32 v[94:95], v[94:95], v[170:171]
    v_cvt_pk_bf16_f32 v80, v80, v81
    v_cvt_pk_bf16_f32 v81, v82, v83
    v_cvt_pk_bf16_f32 v82, v84, v85
    v_cvt_pk_bf16_f32 v83, v86, v87
    v_cvt_pk_bf16_f32 v84, v88, v89
    v_cvt_pk_bf16_f32 v85, v90, v91
    v_cvt_pk_bf16_f32 v86, v92, v93
    v_cvt_pk_bf16_f32 v87, v94, v95
    s_add_u32 s39, s38, 0
    s_add_u32 s40, s38, 65536
    buffer_store_dwordx4 v[80:83], v6, s[20:23], s39 offen sc1
    buffer_store_dwordx4 v[84:87], v6, s[20:23], s40 offen sc1
    s_setprio 0
    s_waitcnt vmcnt(0)
    s_barrier
    s_cmp_lg_u32 s25, 0
    s_cbranch_scc1 L_sig1
    v_mov_b32 v4, 0
    v_mov_b32 v5, 1
    s_mov_b64 exec, 1
    buffer_store_dword v5, v4, s[20:23], s45 offen sc1
    s_mov_b64 exec, -1
L_sig1:
L_p2:
    s_and_b32 s27, s2, 31
    s_lshr_b32 s28, s2, 5
    s_lshl_b32 s28, s28, 3
    s_add_u32 s28, s28, s25
    v_lshlrev_b32 v2, 4, v1
    s_lshl_b32 s29, s27, 16
    s_lshl_b32 s30, s25, 10
    s_add_u32 s31, s29, s30
    s_mul_i32 s32, s25, 1056
    s_add_u32 s32, s32, 65536
    s_lshl_b32 s33, s28, 10
    s_add_u32 s33, s33, s29
    v_mov_b32 v108, 0x3f803f80
    v_mov_b32 v109, 0x3f803f80
    v_mov_b32 v110, 0x3f803f80
    v_mov_b32 v111, 0x3f803f80
    v_mul_u32_u24 v3, 1056, v1
    v_add_u32 v3, 66560, v3
    v_mov_b32 v80, 0
    v_mov_b32 v81, 0
    v_mov_b32 v82, 0
    v_mov_b32 v83, 0
    v_mov_b32 v84, 0
    v_mov_b32 v85, 0
    v_mov_b32 v86, 0
    v_mov_b32 v87, 0
    v_mov_b32 v88, 0
    v_mov_b32 v89, 0
    v_mov_b32 v90, 0
    v_mov_b32 v91, 0
    v_mov_b32 v92, 0
    v_mov_b32 v93, 0
    v_mov_b32 v94, 0
    v_mov_b32 v95, 0
    s_cmp_lg_u32 s25, 3
    s_cbranch_scc1 L_p2_noones
    ds_write_b128 v3, v[108:111]
    ds_write_b128 v3, v[80:83] offset:16
L_p2_noones:
    v_mov_b32 v104, v2
    v_and_b32 v3, 15, v1
    v_lshlrev_b32 v3, 4, v3
    v_lshrrev_b32 v112, 5, v1
    v_lshl_add_u32 v3, v112, 8, v3
    v_mov_b32 v114, 1024
    v_and_b32 v113, 11, v1
    v_cmp_eq_u32 vcc, 0, v113
    v_mov_b32 v115, 1040
    s_nop 0
    v_cndmask_b32 v114, v115, v114, vcc
    v_and_b32 v113, 16, v1
    v_cmp_eq_u32 vcc, 0, v113
    v_subrev_u32 v115, 512, v114
    s_nop 0
    v_cndmask_b32 v105, v114, v3, vcc
    v_cndmask_b32 v106, v115, v3, vcc
    v_add_u32 v105, 65536, v105
    v_add_u32 v106, 65536, v106
    v_mov_b32 v100, 0
    v_mov_b32 v28, 0
    v_mov_b32 v101, 0
    v_mov_b32 v29, 0
    v_mov_b32 v102, 0
    v_mov_b32 v30, 0
    v_mov_b32 v103, 0
    v_mov_b32 v31, 0
    s_cmp_lt_u32 s25, 4
    s_cselect_b32 s42, 99, 1
    s_cselect_b32 s41, 99, 0
    s_mov_b32 s35, 0
    s_lshr_b32 s36, s27, 2
    s_lshl_b32 s36, s36, 8
    s_add_u32 s36, s36, 12288
    s_waitcnt lgkmcnt(0)
    s_cmp_lg_u32 s25, 1
    s_cbranch_scc1 L_wp2
    v_and_b32 v7, 31, v1
    v_lshlrev_b32 v7, 2, v7
    v_add_u32 v7, s36, v7
    v_mov_b32 v8, 1
    s_mov_b32 s46, 25165824
    s_mov_b32 s47, 0
L_poll3:
    s_sleep 24
    buffer_load_dword v6, v7, s[20:23], s46 offen sc1
    s_add_u32 s47, s47, 1
    s_waitcnt vmcnt(0)
    v_cmp_gt_u32 vcc, v8, v6
    s_cmp_gt_u32 s47, 262144
    s_cbranch_scc1 L_poll3_out
    s_cbranch_vccnz L_poll3
L_poll3_out:
L_wp2:
    s_barrier
    s_cmp_lt_u32 s25, 4
    s_cbranch_scc0 L_p2_B
    s_add_u32 s34, s31, 2097152
    s_add_u32 m0, s30, 0
    s_nop 0
    buffer_load_dwordx4 v2, s[20:23], s34 offen sc1 lds
    s_add_u32 s34, s31, 4194304
    s_add_u32 m0, s32, 0
    s_nop 0
    buffer_load_dwordx4 v2, s[20:23], s34 offen sc1 lds
    s_add_u32 s34, s31, 2101248
    s_add_u32 m0, s30, 4096
    s_nop 0
    buffer_load_dwordx4 v2, s[20:23], s34 offen sc1 lds
    s_add_u32 s34, s31, 4198400
    s_add_u32 m0, s32, 4224
    s_nop 0
    buffer_load_dwordx4 v2, s[20:23], s34 offen sc1 lds
    s_add_u32 s34, s31, 2105344
    s_add_u32 m0, s30, 8192
    s_nop 0
    buffer_load_dwordx4 v2, s[20:23], s34 offen sc1 lds
    s_add_u32 s34, s31, 4202496
    s_add_u32 m0, s32, 8448
    s_nop 0
    buffer_load_dwordx4 v2, s[20:23], s34 offen sc1 lds
    s_add_u32 s34, s31, 2109440
    s_add_u32 m0, s30, 12288
    s_nop 0
    buffer_load_dwordx4 v2, s[20:23], s34 offen sc1 lds
    s_add_u32 s34, s31, 4206592
    s_add_u32 m0, s32, 12672
    s_nop 0
    buffer_load_dwordx4 v2, s[20:23], s34 offen sc1 lds
    buffer_load_dwordx4 v[4:7], v2, s[20:23], s33 offen sc1
    s_waitcnt vmcnt(7)
    s_barrier
    s_setprio 1
    s_add_u32 s34, s31, 2113536
    s_add_u32 m0, s30, 16384
    s_nop 0
    buffer_load_dwordx4 v2, s[20:23], s34 offen sc1 lds
    s_add_u32 s34, s31, 4210688
    s_add_u32 m0, s32, 16896
    s_nop 0
    buffer_load_dwordx4 v2, s[20:23], s34 offen sc1 lds
    s_add_u32 s34, s31, 2117632
    s_add_u32 m0, s30, 20480
    s_nop 0
    buffer_load_dwordx4 v2, s[20:23], s34 offen sc1 lds
    s_add_u32 s34, s31, 4214784
    s_add_u32 m0, s32, 21120
    s_nop 0
    buffer_load_dwordx4 v2, s[20:23], s34 offen sc1 lds
    s_add_u32 s34, s31, 2121728
    s_add_u32 m0, s30, 24576
    s_nop 0
    buffer_load_dwordx4 v2, s[20:23], s34 offen sc1 lds
    s_add_u32 s34, s31, 4218880
    s_add_u32 m0, s32, 25344
    s_nop 0
    buffer_load_dwordx4 v2, s[20:23], s34 offen sc1 lds
    s_add_u32 s34, s31, 2125824
    s_add_u32 m0, s30, 28672
    s_nop 0
    buffer_load_dwordx4 v2, s[20:23], s34 offen sc1 lds
    s_add_u32 s34, s31, 4222976
    s_add_u32 m0, s32, 29568
    s_nop 0
    buffer_load_dwordx4 v2, s[20:23], s34 offen sc1 lds
    s_waitcnt vmcnt(8)
    s_barrier
    s_add_u32 s34, s31, 2129920
    s_add_u32 m0, s30, 32768
    s_nop 0
    buffer_load_dwordx4 v2, s[20:23], s34 offen sc1 lds
    s_add_u32 s34, s31, 4227072
    s_add_u32 m0, s32, 33792
    s_nop 0
    buffer_load_dwordx4 v2, s[20:23], s34 offen sc1 lds
    s_add_u32 s34, s31, 2134016
    s_add_u32 m0, s30, 36864
    s_nop 0
    buffer_load_dwordx4 v2, s[20:23], s34 offen sc1 lds
    s_add_u32 s34, s31, 4231168
    s_add_u32 m0, s32, 38016
    s_nop 0
    buffer_load_dwordx4 v2, s[20:23], s34 offen sc1 lds
    s_add_u32 s34, s31, 2138112
    s_add_u32 m0, s30, 40960
    s_nop 0
    buffer_load_dwordx4 v2, s[20:23], s34 offen sc1 lds
    s_add_u32 s34, s31, 4235264
    s_add_u32 m0, s32, 42240
    s_nop 0
    buffer_load_dwordx4 v2, s[20:23], s34 offen sc1 lds
    s_add_u32 s34, s31, 2142208
    s_add_u32 m0, s30, 45056
    s_nop 0
    buffer_load_dwordx4 v2, s[20:23], s34 offen sc1 lds
    s_add_u32 s34, s31, 4239360
    s_add_u32 m0, s32, 46464
    s_nop 0
    buffer_load_dwordx4 v2, s[20:23], s34 offen sc1 lds
    s_add_u32 s34, s31, 2146304
    s_add_u32 m0, s30, 49152
    s_nop 0
    buffer_load_dwordx4 v2, s[20:23], s34 offen sc1 lds
    s_add_u32 s34, s31, 4243456
    s_add_u32 m0, s32, 50688
    s_nop 0
    buffer_load_dwordx4 v2, s[20:23], s34 offen sc1 lds
    s_add_u32 s34, s31, 2150400
    s_add_u32 m0, s30, 53248
    s_nop 0
    buffer_load_dwordx4 v2, s[20:23], s34 offen sc1 lds
    s_add_u32 s34, s31, 4247552
    s_add_u32 m0, s32, 54912
    s_nop 0
    buffer_load_dwordx4 v2, s[20:23], s34 offen sc1 lds
    s_add_u32 s34, s31, 2154496
    s_add_u32 m0, s30, 57344
    s_nop 0
    buffer_load_dwordx4 v2, s[20:23], s34 offen sc1 lds
    s_add_u32 s34, s31, 4251648
    s_add_u32 m0, s32, 59136
    s_nop 0
    buffer_load_dwordx4 v2, s[20:23], s34 offen sc1 lds
    s_add_u32 s34, s31, 2158592
    s_add_u32 m0, s30, 61440
    s_nop 0
    buffer_load_dwordx4 v2, s[20:23], s34 offen sc1 lds
    s_add_u32 s34, s31, 4255744
    s_add_u32 m0, s32, 63360
    s_nop 0
    buffer_load_dwordx4 v2, s[20:23], s34 offen sc1 lds
    s_lshr_b32 s44, s2, 2
    s_cmp_lt_u32 s44, 28
    s_cselect_b32 s16, s60, s62
    s_cselect_b32 s17, s61, s63
    s_cselect_b32 s36, 0, 28
    s_mov_b32 s18, 1835008
    s_mov_b32 s19, 0x20000
    s_sub_u32 s36, s44, s36
    s_lshl_b32 s36, s36, 7
    s_and_b32 s43, s2, 3
    s_lshl_b32 s43, s43, 2
    s_add_u32 s43, s43, s26
    s_mul_i32 s37, s43, 114688
    s_add_u32 s36, s36, s37
    s_cmp_lt_u32 s2, 224
    s_cselect_b32 s36, s36, 0x7ff00000
    v_bfe_u32 v108, v1, 2, 1
    v_bfe_u32 v109, v1, 4, 1
    v_xor_b32 v108, v108, v109
    v_and_b32 v109, 3, v1
    v_lshlrev_b32 v109, 4, v109
    v_lshl_add_u32 v109, v108, 6, v109
    v_lshrrev_b32 v108, 3, v1
    v_mul_u32_u24 v108, 3584, v108
    v_add_u32 v108, v108, v109
    s_lshl_b32 s48, s26, 12
    s_add_u32 s48, s48, 147456
    s_add_u32 m0, s48, 0
    s_nop 0
    buffer_load_dwordx4 v108, s[16:19], s36 offen lds
    s_add_u32 s36, s36, 28672
    s_add_u32 m0, s48, 1024
    s_nop 0
    buffer_load_dwordx4 v108, s[16:19], s36 offen lds
    s_add_u32 s36, s36, 28672
    s_add_u32 m0, s48, 2048
    s_nop 0
    buffer_load_dwordx4 v108, s[16:19], s36 offen lds
    s_add_u32 s36, s36, 28672
    s_add_u32 m0, s48, 3072
    s_nop 0
    buffer_load_dwordx4 v108, s[16:19], s36 offen lds
    s_add_u32 s36, s36, 28672
    s_waitcnt vmcnt(4)
    s_barrier
    v_min_u32 v108, 13, v1
    v_lshlrev_b32 v108, 7, v108
    s_lshl_b32 s36, s2, 2
    s_add_u32 s36, s36, s26
    s_mul_i32 s37, s36, 1792
    s_mov_b32 s16, s12
    s_mov_b32 s17, s13
    s_mov_b32 s18, 0x1c0000
    s_mov_b32 s19, 0x20000
    buffer_load_dword v116, v108, s[16:19], s37 offen
    v_min_u32 v108, 3, v1
    v_lshlrev_b32 v108, 7, v108
    s_lshl_b32 s37, s36, 9
    s_mov_b32 s16, s10
    s_mov_b32 s17, s11
    s_mov_b32 s18, 0x80000
    s_mov_b32 s19, 0x20000
    buffer_load_dword v116, v108, s[16:19], s37 offen
    s_branch L_p2_go
L_p2_B:
    buffer_load_dwordx4 v[4:7], v2, s[20:23], s33 offen sc1
    s_waitcnt vmcnt(0)
    s_barrier
    s_setprio 2
L_p2_go:
    s_waitcnt lgkmcnt(0)
    ds_read_b128 v[8:11], v104 offset:0
    ds_read_b128 v[12:15], v104 offset:1024
    ds_read_b128 v[16:19], v105 offset:0
    ds_read_b128 v[20:23], v106 offset:512
    s_waitcnt lgkmcnt(3)
    v_mfma_f32_32x32x16_bf16 v[48:63], v[8:11], v[4:7], 0
    s_nop 11
    v_max3_f32 v108, v48, v49, v50
    v_max3_f32 v109, v51, v52, v53
    v_max3_f32 v110, v54, v55, v56
    v_max3_f32 v111, v57, v58, v59
    v_max3_f32 v108, v108, v60, v61
    v_max3_f32 v109, v109, v62, v63
    v_max3_f32 v108, v108, v109, v110
    v_max_f32 v108, v108, v111
    v_mov_b32 v109, v108
    s_nop 1
    v_permlane32_swap_b32 v108, v109
    v_max_f32 v108, v108, v109
    v_sub_f32 v64, 0, v108
    v_sub_f32 v65, 0, v108
    v_sub_f32 v66, 0, v108
    v_sub_f32 v67, 0, v108
    v_sub_f32 v68, 0, v108
    v_sub_f32 v69, 0, v108
    v_sub_f32 v70, 0, v108
    v_sub_f32 v71, 0, v108
    v_sub_f32 v72, 0, v108
    v_sub_f32 v73, 0, v108
    v_sub_f32 v74, 0, v108
    v_sub_f32 v75, 0, v108
    v_sub_f32 v76, 0, v108
    v_sub_f32 v77, 0, v108
    v_sub_f32 v78, 0, v108
    v_sub_f32 v79, 0, v108
    s_nop 1
    v_mfma_f32_32x32x16_bf16 v[32:47], v[8:11], v[4:7], v[64:79]
    s_nop 9
    s_lshr_b32 s40, s25, 2
    s_lshl_b32 s40, s40, 3
    s_waitcnt lgkmcnt(0)
.p2align 6
L_p2_loop:
    s_waitcnt lgkmcnt(0)
    v_mfma_f32_32x32x16_bf16 v[48:63], v[12:15], v[4:7], v[64:79]
    ds_read_b128 v[8:11], v104 offset:2048
    v_exp_f32 v32, v32
    v_exp_f32 v33, v33
    v_exp_f32 v34, v34
    v_exp_f32 v35, v35
    v_mfma_f32_32x32x16_bf16 v[80:95], v[28:31], v[100:103], v[80:95]
    ds_read_b128 v[24:27], v105 offset:1056
    ds_read_b128 v[28:31], v106 offset:1568
    v_exp_f32 v36, v36
    v_exp_f32 v37, v37
    v_cvt_pk_bf16_f32 v96, v32, v33
    v_exp_f32 v38, v38
    v_exp_f32 v39, v39
    v_cvt_pk_bf16_f32 v97, v34, v35
    v_exp_f32 v40, v40
    v_exp_f32 v41, v41
    v_cvt_pk_bf16_f32 v98, v36, v37
    v_exp_f32 v42, v42
    v_exp_f32 v43, v43
    v_cvt_pk_bf16_f32 v99, v38, v39
    v_exp_f32 v44, v44
    v_exp_f32 v45, v45
    v_mfma_f32_32x32x16_bf16 v[80:95], v[16:19], v[96:99], v[80:95]
    v_exp_f32 v46, v46
    v_exp_f32 v47, v47
    v_cvt_pk_bf16_f32 v100, v40, v41
    v_cvt_pk_bf16_f32 v101, v42, v43
    v_cvt_pk_bf16_f32 v102, v44, v45
    v_cvt_pk_bf16_f32 v103, v46, v47
    s_waitcnt lgkmcnt(0)
    v_mfma_f32_32x32x16_bf16 v[32:47], v[8:11], v[4:7], v[64:79]
    ds_read_b128 v[12:15], v104 offset:3072
    v_exp_f32 v48, v48
    v_exp_f32 v49, v49
    v_exp_f32 v50, v50
    v_exp_f32 v51, v51
    v_mfma_f32_32x32x16_bf16 v[80:95], v[20:23], v[100:103], v[80:95]
    ds_read_b128 v[16:19], v105 offset:2112
    ds_read_b128 v[20:23], v106 offset:2624
    v_exp_f32 v52, v52
    v_exp_f32 v53, v53
    v_cvt_pk_bf16_f32 v96, v48, v49
    v_exp_f32 v54, v54
    v_exp_f32 v55, v55
    v_cvt_pk_bf16_f32 v97, v50, v51
    v_exp_f32 v56, v56
    v_exp_f32 v57, v57
    v_cvt_pk_bf16_f32 v98, v52, v53
    v_exp_f32 v58, v58
    v_exp_f32 v59, v59
    v_cvt_pk_bf16_f32 v99, v54, v55
    v_exp_f32 v60, v60
    v_exp_f32 v61, v61
    v_mfma_f32_32x32x16_bf16 v[80:95], v[24:27], v[96:99], v[80:95]
    v_exp_f32 v62, v62
    v_exp_f32 v63, v63
    v_cvt_pk_bf16_f32 v100, v56, v57
    v_cvt_pk_bf16_f32 v101, v58, v59
    v_cvt_pk_bf16_f32 v102, v60, v61
    v_cvt_pk_bf16_f32 v103, v62, v63
    s_cmp_lg_u32 s35, s41
    s_cbranch_scc1 L_nb4
    s_barrier
L_nb4:
    s_waitcnt lgkmcnt(0)
    v_mfma_f32_32x32x16_bf16 v[48:63], v[12:15], v[4:7], v[64:79]
    ds_read_b128 v[8:11], v104 offset:4096
    v_exp_f32 v32, v32
    v_exp_f32 v33, v33
    v_exp_f32 v34, v34
    v_exp_f32 v35, v35
    v_mfma_f32_32x32x16_bf16 v[80:95], v[28:31], v[100:103], v[80:95]
    ds_read_b128 v[24:27], v105 offset:3168
    ds_read_b128 v[28:31], v106 offset:3680
    v_exp_f32 v36, v36
    v_exp_f32 v37, v37
    v_cvt_pk_bf16_f32 v96, v32, v33
    v_exp_f32 v38, v38
    v_exp_f32 v39, v39
    v_cvt_pk_bf16_f32 v97, v34, v35
    v_exp_f32 v40, v40
    v_exp_f32 v41, v41
    v_cvt_pk_bf16_f32 v98, v36, v37
    v_exp_f32 v42, v42
    v_exp_f32 v43, v43
    v_cvt_pk_bf16_f32 v99, v38, v39
    v_exp_f32 v44, v44
    v_exp_f32 v45, v45
    v_mfma_f32_32x32x16_bf16 v[80:95], v[16:19], v[96:99], v[80:95]
    v_exp_f32 v46, v46
    v_exp_f32 v47, v47
    v_cvt_pk_bf16_f32 v100, v40, v41
    v_cvt_pk_bf16_f32 v101, v42, v43
    v_cvt_pk_bf16_f32 v102, v44, v45
    v_cvt_pk_bf16_f32 v103, v46, v47
    s_waitcnt lgkmcnt(0)
    v_mfma_f32_32x32x16_bf16 v[32:47], v[8:11], v[4:7], v[64:79]
    ds_read_b128 v[12:15], v104 offset:5120
    v_exp_f32 v48, v48
    v_exp_f32 v49, v49
    v_exp_f32 v50, v50
    v_exp_f32 v51, v51
    v_mfma_f32_32x32x16_bf16 v[80:95], v[20:23], v[100:103], v[80:95]
    ds_read_b128 v[16:19], v105 offset:4224
    ds_read_b128 v[20:23], v106 offset:4736
    v_exp_f32 v52, v52
    v_exp_f32 v53, v53
    v_cvt_pk_bf16_f32 v96, v48, v49
    v_exp_f32 v54, v54
    v_exp_f32 v55, v55
    v_cvt_pk_bf16_f32 v97, v50, v51
    v_exp_f32 v56, v56
    v_exp_f32 v57, v57
    v_cvt_pk_bf16_f32 v98, v52, v53
    v_exp_f32 v58, v58
    v_exp_f32 v59, v59
    v_cvt_pk_bf16_f32 v99, v54, v55
    v_exp_f32 v60, v60
    v_exp_f32 v61, v61
    v_mfma_f32_32x32x16_bf16 v[80:95], v[24:27], v[96:99], v[80:95]
    v_exp_f32 v62, v62
    v_exp_f32 v63, v63
    v_cvt_pk_bf16_f32 v100, v56, v57
    v_cvt_pk_bf16_f32 v101, v58, v59
    v_cvt_pk_bf16_f32 v102, v60, v61
    v_cvt_pk_bf16_f32 v103, v62, v63
    s_waitcnt lgkmcnt(0)
    v_mfma_f32_32x32x16_bf16 v[48:63], v[12:15], v[4:7], v[64:79]
    ds_read_b128 v[8:11], v104 offset:6144
    v_exp_f32 v32, v32
    v_exp_f32 v33, v33
    v_exp_f32 v34, v34
    v_exp_f32 v35, v35
    v_mfma_f32_32x32x16_bf16 v[80:95], v[28:31], v[100:103], v[80:95]
    ds_read_b128 v[24:27], v105 offset:5280
    ds_read_b128 v[28:31], v106 offset:5792
    v_exp_f32 v36, v36
    v_exp_f32 v37, v37
    v_cvt_pk_bf16_f32 v96, v32, v33
    v_exp_f32 v38, v38
    v_exp_f32 v39, v39
    v_cvt_pk_bf16_f32 v97, v34, v35
    v_exp_f32 v40, v40
    v_exp_f32 v41, v41
    v_cvt_pk_bf16_f32 v98, v36, v37
    v_exp_f32 v42, v42
    v_exp_f32 v43, v43
    v_cvt_pk_bf16_f32 v99, v38, v39
    v_exp_f32 v44, v44
    v_exp_f32 v45, v45
    v_mfma_f32_32x32x16_bf16 v[80:95], v[16:19], v[96:99], v[80:95]
    v_exp_f32 v46, v46
    v_exp_f32 v47, v47
    v_cvt_pk_bf16_f32 v100, v40, v41
    v_cvt_pk_bf16_f32 v101, v42, v43
    v_cvt_pk_bf16_f32 v102, v44, v45
    v_cvt_pk_bf16_f32 v103, v46, v47
    s_waitcnt lgkmcnt(0)
    v_mfma_f32_32x32x16_bf16 v[32:47], v[8:11], v[4:7], v[64:79]
    ds_read_b128 v[12:15], v104 offset:7168
    v_exp_f32 v48, v48
    v_exp_f32 v49, v49
    v_exp_f32 v50, v50
    v_exp_f32 v51, v51
    v_mfma_f32_32x32x16_bf16 v[80:95], v[20:23], v[100:103], v[80:95]
    ds_read_b128 v[16:19], v105 offset:6336
    ds_read_b128 v[20:23], v106 offset:6848
    v_exp_f32 v52, v52
    v_exp_f32 v53, v53
    v_cvt_pk_bf16_f32 v96, v48, v49
    v_exp_f32 v54, v54
    v_exp_f32 v55, v55
    v_cvt_pk_bf16_f32 v97, v50, v51
    v_exp_f32 v56, v56
    v_exp_f32 v57, v57
    v_cvt_pk_bf16_f32 v98, v52, v53
    v_exp_f32 v58, v58
    v_exp_f32 v59, v59
    v_cvt_pk_bf16_f32 v99, v54, v55
    v_exp_f32 v60, v60
    v_exp_f32 v61, v61
    v_mfma_f32_32x32x16_bf16 v[80:95], v[24:27], v[96:99], v[80:95]
    v_exp_f32 v62, v62
    v_exp_f32 v63, v63
    v_cvt_pk_bf16_f32 v100, v56, v57
    v_cvt_pk_bf16_f32 v101, v58, v59
    v_cvt_pk_bf16_f32 v102, v60, v61
    v_cvt_pk_bf16_f32 v103, v62, v63
    s_cmp_lg_u32 s35, s42
    s_cbranch_scc1 L_nb5
    s_barrier
L_nb5:
    s_waitcnt lgkmcnt(0)
    v_mfma_f32_32x32x16_bf16 v[48:63], v[12:15], v[4:7], v[64:79]
    ds_read_b128 v[8:11], v104 offset:8192
    v_exp_f32 v32, v32
    v_exp_f32 v33, v33
    v_exp_f32 v34, v34
    v_exp_f32 v35, v35
    v_mfma_f32_32x32x16_bf16 v[80:95], v[28:31], v[100:103], v[80:95]
    ds_read_b128 v[24:27], v105 offset:7392
    ds_read_b128 v[28:31], v106 offset:7904
    v_exp_f32 v36, v36
    v_exp_f32 v37, v37
    v_cvt_pk_bf16_f32 v96, v32, v33
    v_exp_f32 v38, v38
    v_exp_f32 v39, v39
    v_cvt_pk_bf16_f32 v97, v34, v35
    v_exp_f32 v40, v40
    v_exp_f32 v41, v41
    v_cvt_pk_bf16_f32 v98, v36, v37
    v_exp_f32 v42, v42
    v_exp_f32 v43, v43
    v_cvt_pk_bf16_f32 v99, v38, v39
    v_exp_f32 v44, v44
    v_exp_f32 v45, v45
    v_mfma_f32_32x32x16_bf16 v[80:95], v[16:19], v[96:99], v[80:95]
    v_exp_f32 v46, v46
    v_exp_f32 v47, v47
    v_cvt_pk_bf16_f32 v100, v40, v41
    v_cvt_pk_bf16_f32 v101, v42, v43
    v_cvt_pk_bf16_f32 v102, v44, v45
    v_cvt_pk_bf16_f32 v103, v46, v47
    s_waitcnt lgkmcnt(0)
    v_mfma_f32_32x32x16_bf16 v[32:47], v[8:11], v[4:7], v[64:79]
    ds_read_b128 v[12:15], v104 offset:9216
    v_exp_f32 v48, v48
    v_exp_f32 v49, v49
    v_exp_f32 v50, v50
    v_exp_f32 v51, v51
    v_mfma_f32_32x32x16_bf16 v[80:95], v[20:23], v[100:103], v[80:95]
    ds_read_b128 v[16:19], v105 offset:8448
    ds_read_b128 v[20:23], v106 offset:8960
    v_exp_f32 v52, v52
    v_exp_f32 v53, v53
    v_cvt_pk_bf16_f32 v96, v48, v49
    v_exp_f32 v54, v54
    v_exp_f32 v55, v55
    v_cvt_pk_bf16_f32 v97, v50, v51
    v_exp_f32 v56, v56
    v_exp_f32 v57, v57
    v_cvt_pk_bf16_f32 v98, v52, v53
    v_exp_f32 v58, v58
    v_exp_f32 v59, v59
    v_cvt_pk_bf16_f32 v99, v54, v55
    v_exp_f32 v60, v60
    v_exp_f32 v61, v61
    v_mfma_f32_32x32x16_bf16 v[80:95], v[24:27], v[96:99], v[80:95]
    v_exp_f32 v62, v62
    v_exp_f32 v63, v63
    v_cvt_pk_bf16_f32 v100, v56, v57
    v_cvt_pk_bf16_f32 v101, v58, v59
    v_cvt_pk_bf16_f32 v102, v60, v61
    v_cvt_pk_bf16_f32 v103, v62, v63
    v_add_u32 v104, 8192, v104
    v_add_u32 v105, 8448, v105
    v_add_u32 v106, 8448, v106
    s_cmp_eq_u32 s40, 1
    s_cbranch_scc1 L_p2_h1
    s_cmp_eq_u32 s40, 2
    s_cbranch_scc1 L_p2_h2
    s_cmp_eq_u32 s40, 3
    s_cbranch_scc1 L_p2_h3
    s_cmp_eq_u32 s40, 5
    s_cbranch_scc1 L_p2_h5
    s_cmp_eq_u32 s40, 13
    s_cbranch_scc1 L_p2_h13
L_p2_evret:
    s_add_u32 s40, s40, 1
    s_add_u32 s35, s35, 1
    s_cmp_lg_u32 s35, 8
    s_cbranch_scc1 L_p2_loop
    v_mfma_f32_32x32x16_bf16 v[80:95], v[28:31], v[100:103], v[80:95]
    s_waitcnt lgkmcnt(0)
    s_nop 10
    v_max3_f32 v108, abs(v80), abs(v81), abs(v82)
    v_max3_f32 v109, abs(v83), abs(v84), abs(v85)
    v_max3_f32 v108, v108, abs(v86), abs(v87)
    v_add_f32 v110, v80, v81
    v_add_f32 v111, v82, v83
    v_add_f32 v112, v84, v85
    v_add_f32 v113, v86, v87
    v_add_f32 v110, v110, v111
    v_add_f32 v112, v112, v113
    v_add_f32 v110, v110, v112
    v_max_f32 v108, v108, v109
    s_mov_b32 s36, 0x71800000
    s_mov_b32 s37, 0x7f000000
    v_cmp_gt_f32 vcc, s36, v88
    v_cmp_gt_f32 s[38:39], s37, v108
    v_cmp_o_f32 s[48:49], v110, v110
    s_and_b64 vcc, vcc, s[38:39]
    s_and_b64 vcc, vcc, s[48:49]
    s_cmp_eq_u64 vcc, exec
    s_cbranch_scc0 L_p2_slow
L_p2_fin:
    v_rcp_f32 v108, v88
    s_nop 0
    v_mul_f32 v80, v80, v108
    v_mul_f32 v81, v81, v108
    v_mul_f32 v82, v82, v108
    v_mul_f32 v83, v83, v108
    v_mul_f32 v84, v84, v108
    v_mul_f32 v85, v85, v108
    v_mul_f32 v86, v86, v108
    v_mul_f32 v87, v87, v108
    v_cvt_pk_bf16_f32 v80, v80, v81
    v_cvt_pk_bf16_f32 v81, v82, v83
    v_cvt_pk_bf16_f32 v82, v84, v85
    v_cvt_pk_bf16_f32 v83, v86, v87
    s_lshl_b32 s36, s28, 15
    s_lshl_b32 s37, s27, 10
    s_add_u32 s36, s36, s37
    s_add_u32 s36, s36, 6291456
    buffer_store_dwordx4 v[80:83], v2, s[20:23], s36 offen sc1
    s_branch L_p3
L_p2_h1:
    s_cmp_lt_u32 s2, 224
    s_cbranch_scc0 L_side_end
    s_lshr_b32 s44, s2, 2
    s_and_b32 s43, s2, 3
    s_lshl_b32 s43, s43, 2
    s_add_u32 s43, s43, s26
    s_lshl_b32 s48, s26, 12
    s_add_u32 s48, s48, 147456
    v_bfe_u32 v108, v1, 2, 2
    v_lshrrev_b32 v109, 5, v1
    v_lshl_add_u32 v109, v109, 2, v108
    v_lshlrev_b32 v109, 7, v109
    v_lshrrev_b32 v108, 1, v108
    v_lshl_add_u32 v109, v108, 6, v109
    v_bfe_u32 v108, v1, 4, 1
    v_lshl_add_u32 v109, v108, 5, v109
    v_and_b32 v108, 3, v1
    v_lshl_add_u32 v109, v108, 3, v109
    v_add_u32 v109, s48, v109
    v_xor_b32 v110, 64, v109
    v_bfe_u32 v108, v1, 3, 2
    v_mov_b32 v111, 0x3f803f80
    v_cmp_eq_u32 vcc, 0, v108
    v_cmp_eq_u32 s[38:39], 1, v108
    s_nop 0
    v_cndmask_b32 v136, 0, v111, vcc
    v_cndmask_b32 v140, 0, v111, s[38:39]
    v_cndmask_b32 v137, 0, v111, vcc
    v_cndmask_b32 v141, 0, v111, s[38:39]
    v_cndmask_b32 v138, 0, v111, vcc
    v_cndmask_b32 v142, 0, v111, s[38:39]
    v_cndmask_b32 v139, 0, v111, vcc
    v_cndmask_b32 v143, 0, v111, s[38:39]
    v_and_b32 v108, 47, v1
    v_lshlrev_b32 v108, 4, v108
    v_bfe_u32 v111, v1, 4, 1
    v_lshl_add_u32 v108, v111, 15, v108
    s_cmp_lt_u32 s44, 28
    s_cselect_b32 s36, 0, 4291297536
    s_lshl_b32 s37, s44, 17
    s_add_u32 s36, s36, s37
    s_lshl_b32 s37, s43, 11
    s_add_u32 s36, s36, s37
    s_add_u32 s36, s36, 20971520
    s_add_u32 s37, s36, 65536
    s_waitcnt vmcnt(0) lgkmcnt(0)
    ds_read_b64_tr_b16 v[120:121], v109 offset:0
    ds_read_b64_tr_b16 v[122:123], v109 offset:1024
    ds_read_b64_tr_b16 v[124:125], v110 offset:0
    ds_read_b64_tr_b16 v[126:127], v110 offset:1024
    ds_read_b64_tr_b16 v[128:129], v109 offset:2048
    ds_read_b64_tr_b16 v[130:131], v109 offset:3072
    ds_read_b64_tr_b16 v[132:133], v110 offset:2048
    ds_read_b64_tr_b16 v[134:135], v110 offset:3072
    s_waitcnt lgkmcnt(0)
    v_mfma_f32_32x32x16_bf16 v[144:159], v[136:139], v[120:123], 0
    buffer_store_dwordx4 v[120:123], v108, s[20:23], s36 offen offset:0 sc1
    v_mfma_f32_32x32x16_bf16 v[144:159], v[140:143], v[124:127], v[144:159]
    buffer_store_dwordx4 v[124:127], v108, s[20:23], s37 offen offset:0 sc1
    v_mfma_f32_32x32x16_bf16 v[144:159], v[136:139], v[128:131], v[144:159]
    buffer_store_dwordx4 v[128:131], v108, s[20:23], s36 offen offset:1024 sc1
    v_mfma_f32_32x32x16_bf16 v[144:159], v[140:143], v[132:135], v[144:159]
    buffer_store_dwordx4 v[132:135], v108, s[20:23], s37 offen offset:1024 sc1
    v_cmp_gt_u32 vcc, 32, v1
    v_lshlrev_b32 v109, 4, v1
    s_lshl_b32 s36, s44, 10
    s_lshl_b32 s37, s26, 2
    s_add_u32 s36, s36, s37
    s_and_b32 s37, s2, 3
    s_mul_i32 s37, s37, 57344
    s_add_u32 s36, s36, s37
    s_add_u32 s36, s36, 11534336
    s_nop 1
    v_cndmask_b32 v110, v148, v144, vcc
    buffer_store_dword v110, v109, s[20:23], s36 offen sc1
L_side_end:
    s_branch L_p2_evret
L_p2_h2:
    s_lshr_b32 s36, s2, 5
    s_lshl_b32 s36, s36, 8
    s_add_u32 s36, s36, 25176064
    v_mov_b32 v108, 0
    v_mov_b32 v109, 1
    s_waitcnt vmcnt(0)
    s_mov_b64 exec, 1
    buffer_atomic_add v109, v108, s[20:23], s36 offen sc1
    s_mov_b64 exec, -1
    s_lshr_b32 s36, s2, 3
    s_lshl_b32 s36, s36, 2
    s_add_u32 s36, s36, s26
    v_min_u32 v108, 31, v1
    v_lshlrev_b32 v108, 7, v108
    s_lshl_b32 s37, s36, 12
    s_mov_b32 s16, s10
    s_mov_b32 s17, s11
    s_mov_b32 s18, 0x80000
    s_mov_b32 s19, 0x20000
    buffer_load_dword v116, v108, s[16:19], s37 offen
    v_min_u32 v108, 15, v1
    v_lshlrev_b32 v108, 7, v108
    s_and_b32 s38, s2, 7
    s_lshl_b32 s38, s38, 18
    s_lshl_b32 s37, s36, 11
    s_add_u32 s37, s37, s38
    s_mov_b32 s16, s4
    s_mov_b32 s17, s5
    s_mov_b32 s18, 0x200000
    s_mov_b32 s19, 0x20000
    buffer_load_dword v116, v108, s[16:19], s37 offen
    s_branch L_p2_evret
L_p2_h3:
    s_lshr_b32 s36, s2, 3
    s_lshl_b32 s36, s36, 2
    s_add_u32 s36, s36, s26
    s_min_u32 s36, s36, 111
    s_lshl_b32 s36, s36, 15
    s_add_u32 s36, s36, 20971520
    v_lshlrev_b32 v108, 7, v1
    buffer_load_dword v116, v108, s[20:23], s36 offen
    s_add_u32 s36, s36, 8192
    buffer_load_dword v116, v108, s[20:23], s36 offen
    s_add_u32 s36, s36, 8192
    s_branch L_p2_evret
L_p2_h5:
    s_getpc_b64 s[36:37]
L_pc2:
    v_lshlrev_b32 v108, 7, v0
    v_min_u32 v108, L_codeend-L_pc2, v108
    global_load_dword v116, v108, s[36:37]
    s_branch L_p2_evret
L_p2_h13:
    s_setprio 0
    s_branch L_p2_evret
L_p2_slow:
    v_subrev_u32 v104, 65536, v104
    v_subrev_u32 v105, 67584, v105
    v_subrev_u32 v106, 67584, v106
    v_mov_b32 v80, 0
    v_mov_b32 v81, 0
    v_mov_b32 v82, 0
    v_mov_b32 v83, 0
    v_mov_b32 v84, 0
    v_mov_b32 v85, 0
    v_mov_b32 v86, 0
    v_mov_b32 v87, 0
    v_mov_b32 v88, 0
    v_mov_b32 v89, 0
    v_mov_b32 v90, 0
    v_mov_b32 v91, 0
    v_mov_b32 v92, 0
    v_mov_b32 v93, 0
    v_mov_b32 v94, 0
    v_mov_b32 v95, 0
    v_mov_b32 v114, 0xff7fffff
    s_mov_b32 s35, 64
L_p2_sloop:
    ds_read_b128 v[8:11], v104 offset:0
    ds_read_b128 v[16:19], v105 offset:0
    ds_read_b128 v[20:23], v106 offset:512
    s_waitcnt lgkmcnt(0)
    v_mfma_f32_32x32x16_bf16 v[32:47], v[8:11], v[4:7], 0
    s_nop 11
    v_max3_f32 v108, v32, v33, v34
    v_max3_f32 v109, v35, v36, v37
    v_max3_f32 v110, v38, v39, v40
    v_max3_f32 v111, v41, v42, v43
    v_max3_f32 v108, v108, v44, v45
    v_max3_f32 v109, v109, v46, v47
    v_max3_f32 v108, v108, v109, v110
    v_max_f32 v108, v108, v111
    v_mov_b32 v109, v108
    s_nop 1
    v_permlane32_swap_b32 v108, v109
    v_max3_f32 v108, v108, v109, v114
    v_sub_f32 v109, v114, v108
    v_exp_f32 v109, v109
    v_mov_b32 v114, v108
    v_mul_f32 v80, v80, v109
    v_mul_f32 v81, v81, v109
    v_mul_f32 v82, v82, v109
    v_mul_f32 v83, v83, v109
    v_mul_f32 v84, v84, v109
    v_mul_f32 v85, v85, v109
    v_mul_f32 v86, v86, v109
    v_mul_f32 v87, v87, v109
    v_mul_f32 v88, v88, v109
    v_mul_f32 v89, v89, v109
    v_mul_f32 v90, v90, v109
    v_mul_f32 v91, v91, v109
    v_mul_f32 v92, v92, v109
    v_mul_f32 v93, v93, v109
    v_mul_f32 v94, v94, v109
    v_mul_f32 v95, v95, v109
    v_sub_f32 v32, v32, v114
    v_sub_f32 v33, v33, v114
    v_sub_f32 v34, v34, v114
    v_sub_f32 v35, v35, v114
    v_sub_f32 v36, v36, v114
    v_sub_f32 v37, v37, v114
    v_sub_f32 v38, v38, v114
    v_sub_f32 v39, v39, v114
    v_sub_f32 v40, v40, v114
    v_sub_f32 v41, v41, v114
    v_sub_f32 v42, v42, v114
    v_sub_f32 v43, v43, v114
    v_sub_f32 v44, v44, v114
    v_sub_f32 v45, v45, v114
    v_sub_f32 v46, v46, v114
    v_sub_f32 v47, v47, v114
    v_exp_f32 v32, v32
    v_exp_f32 v33, v33
    v_exp_f32 v34, v34
    v_exp_f32 v35, v35
    v_exp_f32 v36, v36
    v_exp_f32 v37, v37
    v_exp_f32 v38, v38
    v_exp_f32 v39, v39
    v_exp_f32 v40, v40
    v_exp_f32 v41, v41
    v_exp_f32 v42, v42
    v_exp_f32 v43, v43
    v_exp_f32 v44, v44
    v_exp_f32 v45, v45
    v_exp_f32 v46, v46
    v_exp_f32 v47, v47
    v_cvt_pk_bf16_f32 v96, v32, v33
    v_cvt_pk_bf16_f32 v100, v40, v41
    v_cvt_pk_bf16_f32 v97, v34, v35
    v_cvt_pk_bf16_f32 v101, v42, v43
    v_cvt_pk_bf16_f32 v98, v36, v37
    v_cvt_pk_bf16_f32 v102, v44, v45
    v_cvt_pk_bf16_f32 v99, v38, v39
    v_cvt_pk_bf16_f32 v103, v46, v47
    s_nop 0
    v_mfma_f32_32x32x16_bf16 v[80:95], v[16:19], v[96:99], v[80:95]
    v_mfma_f32_32x32x16_bf16 v[80:95], v[20:23], v[100:103], v[80:95]
    v_add_u32 v104, 1024, v104
    v_add_u32 v105, 1056, v105
    v_add_u32 v106, 1056, v106
    s_nop 15
    s_sub_u32 s35, s35, 1
    s_cmp_lg_u32 s35, 0
    s_cbranch_scc1 L_p2_sloop
    s_nop 15
    s_branch L_p2_fin
L_p3:
    v_lshlrev_b32 v112, 4, v1
    s_and_b32 s27, s2, 7
    s_lshl_b32 s27, s27, 2
    s_lshr_b32 s28, s2, 3
    s_and_b32 s28, s28, 3
    s_add_u32 s27, s27, s28
    s_lshr_b32 s28, s2, 5
    s_and_b32 s29, s26, 1
    s_lshr_b32 s30, s26, 1
    s_lshl_b32 s31, s27, 1
    s_add_u32 s31, s31, s30
    s_lshr_b32 s45, s2, 5
    s_lshl_b32 s45, s45, 8
    s_add_u32 s45, s45, 25165824
    s_setprio 0
    s_waitcnt vmcnt(0)
    s_barrier
    s_cmp_lg_u32 s25, 0
    s_cbranch_scc1 L_sig6
    v_mov_b32 v4, 0
    v_mov_b32 v5, 1
    s_mov_b64 exec, 1
    buffer_atomic_add v5, v4, s[20:23], s45 offen sc1
    s_mov_b64 exec, -1
L_sig6:
    s_cmp_lt_u32 s25, 4
    s_cbranch_scc1 L_p3C
    s_lshl_b32 s34, s26, 11
    v_lshrrev_b32 v2, 3, v1
    v_bfe_u32 v3, v1, 2, 1
    v_bfe_u32 v4, v1, 4, 1
    v_xor_b32 v3, v3, v4
    v_and_b32 v4, 3, v1
    v_lshlrev_b32 v4, 4, v4
    v_lshl_add_u32 v4, v3, 6, v4
    v_lshl_add_u32 v4, v2, 10, v4
    s_lshl_b32 s35, s26, 14
    s_lshl_b32 s36, s28, 7
    s_add_u32 s35, s35, s36
    v_add_u32 v113, s35, v4
    v_add_u32 v114, 8192-1024, v113
    s_mov_b32 s16, s10
    s_mov_b32 s17, s11
    s_mov_b32 s18, 0x80000
    s_mov_b32 s19, 0x20000
    s_mov_b32 s56, s4
    s_mov_b32 s57, s5
    s_mov_b32 s58, 0x200000
    s_mov_b32 s59, 0x20000
    s_mov_b32 s41, 0
    s_add_u32 m0, s34, 0
    s_nop 0
    buffer_load_dwordx4 v113, s[16:19], s41 offen lds
    buffer_load_dwordx4 v114, s[16:19], s41 offen offset:1024 lds
    s_mov_b32 s41, 65536
    s_add_u32 m0, s34, 8192
    s_nop 0
    buffer_load_dwordx4 v113, s[16:19], s41 offen lds
    buffer_load_dwordx4 v114, s[16:19], s41 offen offset:1024 lds
    s_mov_b32 s41, 131072
    s_add_u32 m0, s34, 16384
    s_nop 0
    buffer_load_dwordx4 v113, s[16:19], s41 offen lds
    buffer_load_dwordx4 v114, s[16:19], s41 offen offset:1024 lds
    s_mov_b32 s41, 196608
    s_add_u32 m0, s34, 24576
    s_nop 0
    buffer_load_dwordx4 v113, s[16:19], s41 offen lds
    buffer_load_dwordx4 v114, s[16:19], s41 offen offset:1024 lds
    s_mov_b32 s41, 262144
    s_add_u32 m0, s34, 32768
    s_nop 0
    buffer_load_dwordx4 v113, s[16:19], s41 offen lds
    buffer_load_dwordx4 v114, s[16:19], s41 offen offset:1024 lds
    s_mov_b32 s41, 327680
    s_add_u32 m0, s34, 40960
    s_nop 0
    buffer_load_dwordx4 v113, s[16:19], s41 offen lds
    buffer_load_dwordx4 v114, s[16:19], s41 offen offset:1024 lds
    s_mov_b32 s41, 393216
    s_add_u32 m0, s34, 49152
    s_nop 0
    buffer_load_dwordx4 v113, s[16:19], s41 offen lds
    buffer_load_dwordx4 v114, s[16:19], s41 offen offset:1024 lds
    s_mov_b32 s41, 458752
    s_add_u32 m0, s34, 57344
    s_nop 0
    buffer_load_dwordx4 v113, s[16:19], s41 offen lds
    buffer_load_dwordx4 v114, s[16:19], s41 offen offset:1024 lds
    v_and_b32 v5, 7, v1
    v_xor_b32 v5, v5, v2
    v_lshlrev_b32 v5, 4, v5
    v_lshl_add_u32 v4, v2, 10, v5
    s_lshl_b32 s38, s27, 16
    s_add_u32 s38, s38, s35
    s_add_u32 m0, s34, 131072
    s_nop 0
    buffer_load_dwordx4 v4, s[56:59], s38 offen lds
    s_add_u32 s38, s38, 8192
    s_add_u32 m0, s34, 132096
    s_nop 0
    buffer_load_dwordx4 v4, s[56:59], s38 offen lds
    s_lshl_b32 s32, s31, 15
    s_lshl_b32 s33, s29, 11
    s_add_u32 s32, s32, s33
    s_add_u32 s32, s32, 6291456
    s_barrier
    s_add_u32 s40, s32, 0
    s_add_u32 m0, s34, 65536
    s_nop 0
    buffer_load_dwordx4 v112, s[20:23], s40 offen sc1 lds
    buffer_load_dwordx4 v112, s[20:23], s40 offen offset:1024 sc1 lds
    s_add_u32 s40, s32, 4096
    s_add_u32 m0, s34, 73728
    s_nop 0
    buffer_load_dwordx4 v112, s[20:23], s40 offen sc1 lds
    buffer_load_dwordx4 v112, s[20:23], s40 offen offset:1024 sc1 lds
    s_add_u32 s40, s32, 8192
    s_add_u32 m0, s34, 81920
    s_nop 0
    buffer_load_dwordx4 v112, s[20:23], s40 offen sc1 lds
    buffer_load_dwordx4 v112, s[20:23], s40 offen offset:1024 sc1 lds
    s_add_u32 s40, s32, 12288
    s_add_u32 m0, s34, 90112
    s_nop 0
    buffer_load_dwordx4 v112, s[20:23], s40 offen sc1 lds
    buffer_load_dwordx4 v112, s[20:23], s40 offen offset:1024 sc1 lds
    s_add_u32 s40, s32, 16384
    s_add_u32 m0, s34, 98304
    s_nop 0
    buffer_load_dwordx4 v112, s[20:23], s40 offen sc1 lds
    buffer_load_dwordx4 v112, s[20:23], s40 offen offset:1024 sc1 lds
    s_add_u32 s40, s32, 20480
    s_add_u32 m0, s34, 106496
    s_nop 0
    buffer_load_dwordx4 v112, s[20:23], s40 offen sc1 lds
    buffer_load_dwordx4 v112, s[20:23], s40 offen offset:1024 sc1 lds
    s_add_u32 s40, s32, 24576
    s_add_u32 m0, s34, 114688
    s_nop 0
    buffer_load_dwordx4 v112, s[20:23], s40 offen sc1 lds
    buffer_load_dwordx4 v112, s[20:23], s40 offen offset:1024 sc1 lds
    s_add_u32 s40, s32, 28672
    s_add_u32 m0, s34, 122880
    s_nop 0
    buffer_load_dwordx4 v112, s[20:23], s40 offen sc1 lds
    buffer_load_dwordx4 v112, s[20:23], s40 offen offset:1024 sc1 lds
    s_waitcnt vmcnt(14)
    s_barrier
    s_waitcnt vmcnt(12)
    s_barrier
    s_waitcnt vmcnt(10)
    s_barrier
    s_waitcnt vmcnt(8)
    s_barrier
    s_waitcnt vmcnt(6)
    s_barrier
    s_waitcnt vmcnt(4)
    s_barrier
    s_waitcnt vmcnt(2)
    s_barrier
    s_waitcnt vmcnt(0)
    s_barrier
    s_and_b32 s27, s2, 7
    s_lshl_b32 s27, s27, 1
    s_lshr_b32 s28, s2, 3
    s_and_b32 s28, s28, 1
    s_add_u32 s27, s27, s28
    s_lshr_b32 s28, s2, 4
    s_lshl_b32 s29, s27, 2
    s_add_u32 s29, s29, s26
    s_lshl_b32 s38, s29, 15
    s_add_u32 s38, s38, 8388608
    s_lshl_b32 s40, s26, 12
    s_add_u32 s40, s40, 86016
    s_cmp_lt_u32 s25, 4
    s_cselect_b32 s31, 2, 5
    s_cselect_b32 s35, 20, 0
    s_mul_i32 s31, s31, s26
    s_add_u32 s31, s31, s35
    s_lshl_b32 s34, s31, 10
    s_mul_i32 s32, s28, 229376
    s_add_u32 s32, s32, 20971520
    s_mov_b32 s16, s12
    s_mov_b32 s17, s13
    s_mov_b32 s18, 0x1c0000
    s_mov_b32 s19, 0x20000
    s_mul_i32 s42, s26, 7
    s_add_u32 s36, s42, 0
    s_lshr_b32 s37, s36, 2
    s_lshl_b32 s37, s37, 15
    s_and_b32 s39, s36, 3
    s_lshl_b32 s39, s39, 10
    s_add_u32 s37, s37, s39
    v_add_u32 v120, s37, v112
    s_add_u32 s36, s42, 1
    s_lshr_b32 s37, s36, 2
    s_lshl_b32 s37, s37, 15
    s_and_b32 s39, s36, 3
    s_lshl_b32 s39, s39, 10
    s_add_u32 s37, s37, s39
    v_add_u32 v121, s37, v112
    s_add_u32 s36, s42, 2
    s_lshr_b32 s37, s36, 2
    s_lshl_b32 s37, s37, 15
    s_and_b32 s39, s36, 3
    s_lshl_b32 s39, s39, 10
    s_add_u32 s37, s37, s39
    v_add_u32 v122, s37, v112
    s_add_u32 s36, s42, 3
    s_lshr_b32 s37, s36, 2
    s_lshl_b32 s37, s37, 15
    s_and_b32 s39, s36, 3
    s_lshl_b32 s39, s39, 10
    s_add_u32 s37, s37, s39
    v_add_u32 v123, s37, v112
    s_add_u32 s36, s42, 4
    s_lshr_b32 s37, s36, 2
    s_lshl_b32 s37, s37, 15
    s_and_b32 s39, s36, 3
    s_lshl_b32 s39, s39, 10
    s_add_u32 s37, s37, s39
    v_add_u32 v124, s37, v112
    s_add_u32 s36, s42, 5
    s_lshr_b32 s37, s36, 2
    s_lshl_b32 s37, s37, 15
    s_and_b32 s39, s36, 3
    s_lshl_b32 s39, s39, 10
    s_add_u32 s37, s37, s39
    v_add_u32 v125, s37, v112
    s_add_u32 s36, s42, 6
    s_lshr_b32 s37, s36, 2
    s_lshl_b32 s37, s37, 15
    s_and_b32 s39, s36, 3
    s_lshl_b32 s39, s39, 10
    s_add_u32 s37, s37, s39
    v_add_u32 v126, s37, v112
    s_lshl_b32 s42, s42, 10
    s_barrier
    s_add_u32 s37, s32, 0
    s_add_u32 m0, s42, 0
    s_nop 0
    buffer_load_dwordx4 v120, s[20:23], s37 offen sc1 lds
    s_add_u32 m0, s42, 1024
    s_nop 0
    buffer_load_dwordx4 v121, s[20:23], s37 offen sc1 lds
    s_add_u32 m0, s42, 2048
    s_nop 0
    buffer_load_dwordx4 v122, s[20:23], s37 offen sc1 lds
    s_add_u32 m0, s42, 3072
    s_nop 0
    buffer_load_dwordx4 v123, s[20:23], s37 offen sc1 lds
    s_barrier
    s_add_u32 m0, s42, 4096
    s_nop 0
    buffer_load_dwordx4 v124, s[20:23], s37 offen sc1 lds
    s_add_u32 m0, s42, 5120
    s_nop 0
    buffer_load_dwordx4 v125, s[20:23], s37 offen sc1 lds
    s_add_u32 m0, s42, 6144
    s_nop 0
    buffer_load_dwordx4 v126, s[20:23], s37 offen sc1 lds
    s_add_u32 s37, s32, 4096
    s_add_u32 m0, s42, 28672
    s_nop 0
    buffer_load_dwordx4 v120, s[20:23], s37 offen sc1 lds
    s_add_u32 m0, s42, 29696
    s_nop 0
    buffer_load_dwordx4 v121, s[20:23], s37 offen sc1 lds
    s_add_u32 m0, s42, 30720
    s_nop 0
    buffer_load_dwordx4 v122, s[20:23], s37 offen sc1 lds
    s_add_u32 m0, s42, 31744
    s_nop 0
    buffer_load_dwordx4 v123, s[20:23], s37 offen sc1 lds
    s_add_u32 m0, s42, 32768
    s_nop 0
    buffer_load_dwordx4 v124, s[20:23], s37 offen sc1 lds
    s_add_u32 m0, s42, 33792
    s_nop 0
    buffer_load_dwordx4 v125, s[20:23], s37 offen sc1 lds
    s_add_u32 m0, s42, 34816
    s_nop 0
    buffer_load_dwordx4 v126, s[20:23], s37 offen sc1 lds
    s_add_u32 s37, s32, 8192
    s_add_u32 m0, s42, 57344
    s_nop 0
    buffer_load_dwordx4 v120, s[20:23], s37 offen sc1 lds
    s_add_u32 m0, s42, 58368
    s_nop 0
    buffer_load_dwordx4 v121, s[20:23], s37 offen sc1 lds
    s_add_u32 m0, s42, 59392
    s_nop 0
    buffer_load_dwordx4 v122, s[20:23], s37 offen sc1 lds
    s_add_u32 m0, s42, 60416
    s_nop 0
    buffer_load_dwordx4 v123, s[20:23], s37 offen sc1 lds
    s_add_u32 m0, s42, 61440
    s_nop 0
    buffer_load_dwordx4 v124, s[20:23], s37 offen sc1 lds
    s_add_u32 m0, s42, 62464
    s_nop 0
    buffer_load_dwordx4 v125, s[20:23], s37 offen sc1 lds
    s_add_u32 m0, s42, 63488
    s_nop 0
    buffer_load_dwordx4 v126, s[20:23], s37 offen sc1 lds
    s_barrier
    s_add_u32 s35, s31, 0
    s_lshr_b32 s36, s35, 2
    s_lshl_b32 s36, s36, 15
    s_and_b32 s35, s35, 3
    s_lshl_b32 s35, s35, 10
    s_add_u32 s35, s35, s36
    v_add_u32 v88, s35, v112
    s_add_u32 s35, s31, 1
    s_lshr_b32 s36, s35, 2
    s_lshl_b32 s36, s36, 15
    s_and_b32 s35, s35, 3
    s_lshl_b32 s35, s35, 10
    s_add_u32 s35, s35, s36
    v_add_u32 v89, s35, v112
    s_add_u32 s35, s31, 2
    s_lshr_b32 s36, s35, 2
    s_lshl_b32 s36, s36, 15
    s_and_b32 s35, s35, 3
    s_lshl_b32 s35, s35, 10
    s_add_u32 s35, s35, s36
    v_add_u32 v90, s35, v112
    s_add_u32 s35, s31, 3
    s_lshr_b32 s36, s35, 2
    s_lshl_b32 s36, s36, 15
    s_and_b32 s35, s35, 3
    s_lshl_b32 s35, s35, 10
    s_add_u32 s35, s35, s36
    v_add_u32 v91, s35, v112
    s_add_u32 s35, s31, 4
    s_lshr_b32 s36, s35, 2
    s_lshl_b32 s36, s36, 15
    s_and_b32 s35, s35, 3
    s_lshl_b32 s35, s35, 10
    s_add_u32 s35, s35, s36
    v_add_u32 v92, s35, v112
    v_lshrrev_b32 v3, 5, v1
    v_mov_b32 v10, v112
    v_add_u32 v11, 28672, v10
    v_add_u32 v12, 57344, v10
    v_add_u32 v13, s40, v112
    v_lshlrev_b32 v14, 4, v3
    v_add_u32 v14, 135168, v14
    s_waitcnt vmcnt(14) lgkmcnt(0)
    s_barrier
    ds_read_b128 v[16:19], v13 offset:0
    ds_read_b128 v[24:27], v10 offset:16384
    ds_read_b128 v[28:31], v10 offset:20480
    ds_read_b128 v[32:35], v10 offset:24576
    ds_read_b128 v[20:23], v13 offset:1024
    s_waitcnt lgkmcnt(3)
    v_mfma_f32_32x32x16_bf16 v[40:55], v[24:27], v[16:19], 0
    ds_read_b128 v[24:27], v10 offset:17408
    s_waitcnt lgkmcnt(3)
    v_mfma_f32_32x32x16_bf16 v[56:71], v[28:31], v[16:19], 0
    ds_read_b128 v[28:31], v10 offset:21504
    s_waitcnt lgkmcnt(3)
    v_mfma_f32_32x32x16_bf16 v[72:87], v[32:35], v[16:19], 0
    ds_read_b128 v[32:35], v10 offset:25600
    ds_read_b128 v[16:19], v13 offset:2048
    s_waitcnt lgkmcnt(3)
    v_mfma_f32_32x32x16_bf16 v[40:55], v[24:27], v[20:23], v[40:55]
    ds_read_b128 v[24:27], v10 offset:18432
    s_waitcnt lgkmcnt(3)
    v_mfma_f32_32x32x16_bf16 v[56:71], v[28:31], v[20:23], v[56:71]
    ds_read_b128 v[28:31], v10 offset:22528
    s_waitcnt lgkmcnt(3)
    v_mfma_f32_32x32x16_bf16 v[72:87], v[32:35], v[20:23], v[72:87]
    ds_read_b128 v[32:35], v10 offset:26624
    ds_read_b128 v[20:23], v13 offset:3072
    s_waitcnt lgkmcnt(3)
    v_mfma_f32_32x32x16_bf16 v[40:55], v[24:27], v[16:19], v[40:55]
    ds_read_b128 v[24:27], v10 offset:19456
    s_waitcnt lgkmcnt(3)
    v_mfma_f32_32x32x16_bf16 v[56:71], v[28:31], v[16:19], v[56:71]
    ds_read_b128 v[28:31], v10 offset:23552
    s_waitcnt lgkmcnt(3)
    v_mfma_f32_32x32x16_bf16 v[72:87], v[32:35], v[16:19], v[72:87]
    ds_read_b128 v[32:35], v10 offset:27648
    s_waitcnt vmcnt(7) lgkmcnt(0)
    s_barrier
    ds_read_b128 v[16:19], v13 offset:16384
    v_mfma_f32_32x32x16_bf16 v[40:55], v[24:27], v[20:23], v[40:55]
    ds_read_b128 v[24:27], v11 offset:16384
    s_add_u32 s37, s32, 12288
    s_add_u32 m0, s34, 0
    s_nop 0
    buffer_load_dwordx4 v88, s[20:23], s37 offen sc1 lds
    v_mfma_f32_32x32x16_bf16 v[56:71], v[28:31], v[20:23], v[56:71]
    ds_read_b128 v[28:31], v11 offset:20480
    s_add_u32 m0, s34, 1024
    s_nop 0
    buffer_load_dwordx4 v89, s[20:23], s37 offen sc1 lds
    v_mfma_f32_32x32x16_bf16 v[72:87], v[32:35], v[20:23], v[72:87]
    ds_read_b128 v[32:35], v11 offset:24576
    s_add_u32 m0, s34, 2048
    s_nop 0
    buffer_load_dwordx4 v90, s[20:23], s37 offen sc1 lds
    ds_read_b128 v[20:23], v13 offset:17408
    s_waitcnt lgkmcnt(3)
    v_mfma_f32_32x32x16_bf16 v[40:55], v[24:27], v[16:19], v[40:55]
    ds_read_b128 v[24:27], v11 offset:17408
    s_add_u32 m0, s34, 3072
    s_nop 0
    buffer_load_dwordx4 v91, s[20:23], s37 offen sc1 lds
    s_waitcnt lgkmcnt(3)
    v_mfma_f32_32x32x16_bf16 v[56:71], v[28:31], v[16:19], v[56:71]
    ds_read_b128 v[28:31], v11 offset:21504
    s_add_u32 m0, s34, 4096
    s_nop 0
    buffer_load_dwordx4 v92, s[20:23], s37 offen sc1 lds
    s_waitcnt lgkmcnt(3)
    v_mfma_f32_32x32x16_bf16 v[72:87], v[32:35], v[16:19], v[72:87]
    ds_read_b128 v[32:35], v11 offset:25600
    s_lshl_b32 s43, s29, 12
    s_add_u32 s43, s43, 10485760
    v_lshlrev_b32 v8, 3, v1
    buffer_load_dwordx2 v[128:129], v8, s[20:23], s43 offen sc1
    ds_read_b128 v[16:19], v13 offset:18432
    s_waitcnt lgkmcnt(3)
    v_mfma_f32_32x32x16_bf16 v[40:55], v[24:27], v[20:23], v[40:55]
    ds_read_b128 v[24:27], v11 offset:18432
    buffer_load_dwordx2 v[130:131], v8, s[20:23], s43 offen offset:512 sc1
    s_waitcnt lgkmcnt(3)
    v_mfma_f32_32x32x16_bf16 v[56:71], v[28:31], v[20:23], v[56:71]
    ds_read_b128 v[28:31], v11 offset:22528
    s_waitcnt lgkmcnt(3)
    v_mfma_f32_32x32x16_bf16 v[72:87], v[32:35], v[20:23], v[72:87]
    ds_read_b128 v[32:35], v11 offset:26624
    buffer_load_dwordx2 v[132:133], v8, s[20:23], s43 offen offset:1024 sc1
    ds_read_b128 v[20:23], v13 offset:19456
    s_waitcnt lgkmcnt(3)
    v_mfma_f32_32x32x16_bf16 v[40:55], v[24:27], v[16:19], v[40:55]
    ds_read_b128 v[24:27], v11 offset:19456
    buffer_load_dwordx2 v[134:135], v8, s[20:23], s43 offen offset:1536 sc1
    s_waitcnt lgkmcnt(3)
    v_mfma_f32_32x32x16_bf16 v[56:71], v[28:31], v[16:19], v[56:71]
    ds_read_b128 v[28:31], v11 offset:23552
    s_waitcnt lgkmcnt(3)
    v_mfma_f32_32x32x16_bf16 v[72:87], v[32:35], v[16:19], v[72:87]
    ds_read_b128 v[32:35], v11 offset:27648
    buffer_load_dwordx2 v[136:137], v8, s[20:23], s43 offen offset:2048 sc1
    buffer_load_dwordx2 v[138:139], v8, s[20:23], s43 offen offset:2560 sc1
    buffer_load_dwordx2 v[140:141], v8, s[20:23], s43 offen offset:3072 sc1
    buffer_load_dwordx2 v[142:143], v8, s[20:23], s43 offen offset:3584 sc1
    s_waitcnt vmcnt(13) lgkmcnt(0)
    s_barrier
    ds_read_b128 v[16:19], v13 offset:32768
    v_mfma_f32_32x32x16_bf16 v[40:55], v[24:27], v[20:23], v[40:55]
    ds_read_b128 v[24:27], v12 offset:16384
    s_add_u32 s37, s32, 16384
    s_add_u32 m0, s34, 28672
    s_nop 0
    buffer_load_dwordx4 v88, s[20:23], s37 offen sc1 lds
    v_mfma_f32_32x32x16_bf16 v[56:71], v[28:31], v[20:23], v[56:71]
    ds_read_b128 v[28:31], v12 offset:20480
    v_mfma_f32_32x32x16_bf16 v[72:87], v[32:35], v[20:23], v[72:87]
    ds_read_b128 v[32:35], v12 offset:24576
    s_add_u32 m0, s34, 29696
    s_nop 0
    buffer_load_dwordx4 v89, s[20:23], s37 offen sc1 lds
    ds_read_b128 v[20:23], v13 offset:33792
    s_waitcnt lgkmcnt(3)
    v_mfma_f32_32x32x16_bf16 v[40:55], v[24:27], v[16:19], v[40:55]
    ds_read_b128 v[24:27], v12 offset:17408
    s_add_u32 m0, s34, 30720
    s_nop 0
    buffer_load_dwordx4 v90, s[20:23], s37 offen sc1 lds
    s_waitcnt lgkmcnt(3)
    v_mfma_f32_32x32x16_bf16 v[56:71], v[28:31], v[16:19], v[56:71]
    ds_read_b128 v[28:31], v12 offset:21504
    s_waitcnt lgkmcnt(3)
    v_mfma_f32_32x32x16_bf16 v[72:87], v[32:35], v[16:19], v[72:87]
    ds_read_b128 v[32:35], v12 offset:25600
    s_add_u32 m0, s34, 31744
    s_nop 0
    buffer_load_dwordx4 v91, s[20:23], s37 offen sc1 lds
    ds_read_b128 v[16:19], v13 offset:34816
    s_waitcnt lgkmcnt(3)
    v_mfma_f32_32x32x16_bf16 v[40:55], v[24:27], v[20:23], v[40:55]
    ds_read_b128 v[24:27], v12 offset:18432
    s_add_u32 m0, s34, 32768
    s_nop 0
    buffer_load_dwordx4 v92, s[20:23], s37 offen sc1 lds
    s_waitcnt lgkmcnt(3)
    v_mfma_f32_32x32x16_bf16 v[56:71], v[28:31], v[20:23], v[56:71]
    ds_read_b128 v[28:31], v12 offset:22528
    s_waitcnt lgkmcnt(3)
    v_mfma_f32_32x32x16_bf16 v[72:87], v[32:35], v[20:23], v[72:87]
    ds_read_b128 v[32:35], v12 offset:26624
    ds_read_b128 v[20:23], v13 offset:35840
    s_waitcnt lgkmcnt(3)
    v_mfma_f32_32x32x16_bf16 v[40:55], v[24:27], v[16:19], v[40:55]
    ds_read_b128 v[24:27], v12 offset:19456
    s_waitcnt lgkmcnt(3)
    v_mfma_f32_32x32x16_bf16 v[56:71], v[28:31], v[16:19], v[56:71]
    ds_read_b128 v[28:31], v12 offset:23552
    s_waitcnt lgkmcnt(3)
    v_mfma_f32_32x32x16_bf16 v[72:87], v[32:35], v[16:19], v[72:87]
    ds_read_b128 v[32:35], v12 offset:27648
    s_waitcnt vmcnt(13) lgkmcnt(0)
    s_barrier
    ds_read_b128 v[16:19], v13 offset:0
    v_mfma_f32_32x32x16_bf16 v[40:55], v[24:27], v[20:23], v[40:55]
    ds_read_b128 v[24:27], v10 offset:16384
    s_add_u32 s37, s32, 20480
    s_add_u32 m0, s34, 57344
    s_nop 0
    buffer_load_dwordx4 v88, s[20:23], s37 offen sc1 lds
    v_mfma_f32_32x32x16_bf16 v[56:71], v[28:31], v[20:23], v[56:71]
    ds_read_b128 v[28:31], v10 offset:20480
    v_mfma_f32_32x32x16_bf16 v[72:87], v[32:35], v[20:23], v[72:87]
    ds_read_b128 v[32:35], v10 offset:24576
    s_add_u32 m0, s34, 58368
    s_nop 0
    buffer_load_dwordx4 v89, s[20:23], s37 offen sc1 lds
    ds_read_b128 v[20:23], v13 offset:1024
    s_waitcnt lgkmcnt(3)
    v_mfma_f32_32x32x16_bf16 v[40:55], v[24:27], v[16:19], v[40:55]
    ds_read_b128 v[24:27], v10 offset:17408
    s_add_u32 m0, s34, 59392
    s_nop 0
    buffer_load_dwordx4 v90, s[20:23], s37 offen sc1 lds
    s_waitcnt lgkmcnt(3)
    v_mfma_f32_32x32x16_bf16 v[56:71], v[28:31], v[16:19], v[56:71]
    ds_read_b128 v[28:31], v10 offset:21504
    s_waitcnt lgkmcnt(3)
    v_mfma_f32_32x32x16_bf16 v[72:87], v[32:35], v[16:19], v[72:87]
    ds_read_b128 v[32:35], v10 offset:25600
    s_add_u32 m0, s34, 60416
    s_nop 0
    buffer_load_dwordx4 v91, s[20:23], s37 offen sc1 lds
    ds_read_b128 v[16:19], v13 offset:2048
    s_waitcnt lgkmcnt(3)
    v_mfma_f32_32x32x16_bf16 v[40:55], v[24:27], v[20:23], v[40:55]
    ds_read_b128 v[24:27], v10 offset:18432
    s_add_u32 m0, s34, 61440
    s_nop 0
    buffer_load_dwordx4 v92, s[20:23], s37 offen sc1 lds
    s_waitcnt lgkmcnt(3)
    v_mfma_f32_32x32x16_bf16 v[56:71], v[28:31], v[20:23], v[56:71]
    ds_read_b128 v[28:31], v10 offset:22528
    s_waitcnt lgkmcnt(3)
    v_mfma_f32_32x32x16_bf16 v[72:87], v[32:35], v[20:23], v[72:87]
    ds_read_b128 v[32:35], v10 offset:26624
    s_waitcnt vmcnt(10)
    v_add_f32 v128, v128, v130
    v_add_f32 v129, v129, v131
    v_add_f32 v128, v128, v132
    v_add_f32 v129, v129, v133
    v_add_f32 v128, v128, v134
    v_add_f32 v129, v129, v135
    v_add_f32 v128, v128, v136
    v_add_f32 v129, v129, v137
    v_add_f32 v128, v128, v138
    v_add_f32 v129, v129, v139
    v_add_f32 v128, v128, v140
    v_add_f32 v129, v129, v141
    v_add_f32 v128, v128, v142
    v_add_f32 v129, v129, v143
    v_mov_b32 v130, v128
    v_mov_b32 v131, v129
    s_nop 0
    v_permlane32_swap_b32 v128, v130
    v_permlane32_swap_b32 v129, v131
    v_add_f32 v128, v128, v130
    v_add_f32 v129, v129, v131
    v_mul_f32 v117, 0x3b000000, v128
    v_mul_f32 v122, 0x3b000000, v129
    v_fma_f32 v122, -v117, v117, v122
    v_max_f32 v122, 0, v122
    v_add_f32 v122, 0x3727c5ac, v122
    v_rsq_f32 v120, v122
    s_nop 0
    v_mul_f32 v120, 0xbfb8aa3b, v120
    v_mov_b32 v121, v120
    v_mov_b32 v123, v122
    v_sub_f32 v118, 0, v117
    v_sub_f32 v119, 0, v117
    ds_read_b128 v[20:23], v13 offset:3072
    s_waitcnt lgkmcnt(3)
    v_mfma_f32_32x32x16_bf16 v[40:55], v[24:27], v[16:19], v[40:55]
    ds_read_b128 v[24:27], v10 offset:19456
    s_waitcnt lgkmcnt(3)
    v_mfma_f32_32x32x16_bf16 v[56:71], v[28:31], v[16:19], v[56:71]
    ds_read_b128 v[28:31], v10 offset:23552
    s_waitcnt lgkmcnt(3)
    v_mfma_f32_32x32x16_bf16 v[72:87], v[32:35], v[16:19], v[72:87]
    ds_read_b128 v[32:35], v10 offset:27648
    s_waitcnt vmcnt(5) lgkmcnt(0)
    s_barrier
    ds_read_b128 v[16:19], v13 offset:16384
    v_mfma_f32_32x32x16_bf16 v[40:55], v[24:27], v[20:23], v[40:55]
    ds_read_b128 v[24:27], v11 offset:16384
    s_add_u32 s37, s32, 24576
    s_add_u32 m0, s34, 0
    s_nop 0
    buffer_load_dwordx4 v88, s[20:23], s37 offen sc1 lds
    v_mfma_f32_32x32x16_bf16 v[56:71], v[28:31], v[20:23], v[56:71]
    ds_read_b128 v[28:31], v11 offset:20480
    v_mfma_f32_32x32x16_bf16 v[72:87], v[32:35], v[20:23], v[72:87]
    ds_read_b128 v[32:35], v11 offset:24576
    s_add_u32 m0, s34, 1024
    s_nop 0
    buffer_load_dwordx4 v89, s[20:23], s37 offen sc1 lds
    ds_read_b128 v[20:23], v13 offset:17408
    s_waitcnt lgkmcnt(3)
    v_mfma_f32_32x32x16_bf16 v[40:55], v[24:27], v[16:19], v[40:55]
    ds_read_b128 v[24:27], v11 offset:17408
    s_add_u32 m0, s34, 2048
    s_nop 0
    buffer_load_dwordx4 v90, s[20:23], s37 offen sc1 lds
    s_waitcnt lgkmcnt(3)
    v_mfma_f32_32x32x16_bf16 v[56:71], v[28:31], v[16:19], v[56:71]
    ds_read_b128 v[28:31], v11 offset:21504
    s_waitcnt lgkmcnt(3)
    v_mfma_f32_32x32x16_bf16 v[72:87], v[32:35], v[16:19], v[72:87]
    ds_read_b128 v[32:35], v11 offset:25600
    s_add_u32 m0, s34, 3072
    s_nop 0
    buffer_load_dwordx4 v91, s[20:23], s37 offen sc1 lds
    ds_read_b128 v[16:19], v13 offset:18432
    s_waitcnt lgkmcnt(3)
    v_mfma_f32_32x32x16_bf16 v[40:55], v[24:27], v[20:23], v[40:55]
    ds_read_b128 v[24:27], v11 offset:18432
    s_add_u32 m0, s34, 4096
    s_nop 0
    buffer_load_dwordx4 v92, s[20:23], s37 offen sc1 lds
    s_waitcnt lgkmcnt(3)
    v_mfma_f32_32x32x16_bf16 v[56:71], v[28:31], v[20:23], v[56:71]
    ds_read_b128 v[28:31], v11 offset:22528
    s_waitcnt lgkmcnt(3)
    v_mfma_f32_32x32x16_bf16 v[72:87], v[32:35], v[20:23], v[72:87]
    ds_read_b128 v[32:35], v11 offset:26624
    ds_read_b128 v[20:23], v13 offset:19456
    s_waitcnt lgkmcnt(3)
    v_mfma_f32_32x32x16_bf16 v[40:55], v[24:27], v[16:19], v[40:55]
    ds_read_b128 v[24:27], v11 offset:19456
    s_waitcnt lgkmcnt(3)
    v_mfma_f32_32x32x16_bf16 v[56:71], v[28:31], v[16:19], v[56:71]
    ds_read_b128 v[28:31], v11 offset:23552
    s_waitcnt lgkmcnt(3)
    v_mfma_f32_32x32x16_bf16 v[72:87], v[32:35], v[16:19], v[72:87]
    ds_read_b128 v[32:35], v11 offset:27648
    s_waitcnt vmcnt(5) lgkmcnt(0)
    s_barrier
    ds_read_b128 v[16:19], v13 offset:32768
    v_mfma_f32_32x32x16_bf16 v[40:55], v[24:27], v[20:23], v[40:55]
    ds_read_b128 v[24:27], v12 offset:16384
    s_add_u32 s37, s32, 28672
    s_add_u32 m0, s34, 28672
    s_nop 0
    buffer_load_dwordx4 v88, s[20:23], s37 offen sc1 lds
    v_mfma_f32_32x32x16_bf16 v[56:71], v[28:31], v[20:23], v[56:71]
    ds_read_b128 v[28:31], v12 offset:20480
    v_mfma_f32_32x32x16_bf16 v[72:87], v[32:35], v[20:23], v[72:87]
    ds_read_b128 v[32:35], v12 offset:24576
    s_add_u32 m0, s34, 29696
    s_nop 0
    buffer_load_dwordx4 v89, s[20:23], s37 offen sc1 lds
    ds_read_b128 v[20:23], v13 offset:33792
    s_waitcnt lgkmcnt(3)
    v_mfma_f32_32x32x16_bf16 v[40:55], v[24:27], v[16:19], v[40:55]
    ds_read_b128 v[24:27], v12 offset:17408
    s_add_u32 m0, s34, 30720
    s_nop 0
    buffer_load_dwordx4 v90, s[20:23], s37 offen sc1 lds
    s_waitcnt lgkmcnt(3)
    v_mfma_f32_32x32x16_bf16 v[56:71], v[28:31], v[16:19], v[56:71]
    ds_read_b128 v[28:31], v12 offset:21504
    s_waitcnt lgkmcnt(3)
    v_mfma_f32_32x32x16_bf16 v[72:87], v[32:35], v[16:19], v[72:87]
    ds_read_b128 v[32:35], v12 offset:25600
    s_add_u32 m0, s34, 31744
    s_nop 0
    buffer_load_dwordx4 v91, s[20:23], s37 offen sc1 lds
    ds_read_b128 v[16:19], v13 offset:34816
    s_waitcnt lgkmcnt(3)
    v_mfma_f32_32x32x16_bf16 v[40:55], v[24:27], v[20:23], v[40:55]
    ds_read_b128 v[24:27], v12 offset:18432
    s_add_u32 m0, s34, 32768
    s_nop 0
    buffer_load_dwordx4 v92, s[20:23], s37 offen sc1 lds
    s_waitcnt lgkmcnt(3)
    v_mfma_f32_32x32x16_bf16 v[56:71], v[28:31], v[20:23], v[56:71]
    ds_read_b128 v[28:31], v12 offset:22528
    s_waitcnt lgkmcnt(3)
    v_mfma_f32_32x32x16_bf16 v[72:87], v[32:35], v[20:23], v[72:87]
    ds_read_b128 v[32:35], v12 offset:26624
    ds_read_b128 v[20:23], v13 offset:35840
    s_waitcnt lgkmcnt(3)
    v_mfma_f32_32x32x16_bf16 v[40:55], v[24:27], v[16:19], v[40:55]
    ds_read_b128 v[24:27], v12 offset:19456
    s_waitcnt lgkmcnt(3)
    v_mfma_f32_32x32x16_bf16 v[56:71], v[28:31], v[16:19], v[56:71]
    ds_read_b128 v[28:31], v12 offset:23552
    s_waitcnt lgkmcnt(3)
    v_mfma_f32_32x32x16_bf16 v[72:87], v[32:35], v[16:19], v[72:87]
    ds_read_b128 v[32:35], v12 offset:27648
    s_waitcnt vmcnt(5) lgkmcnt(0)
    s_barrier
    ds_read_b128 v[16:19], v13 offset:0
    v_mfma_f32_32x32x16_bf16 v[40:55], v[24:27], v[20:23], v[40:55]
    ds_read_b128 v[24:27], v10 offset:16384
    v_min_u32 v5, 55, v1
    v_lshlrev_b32 v6, 7, v5
    s_lshr_b32 s37, s2, 3
    s_lshl_b32 s37, s37, 2
    s_add_u32 s37, s37, s26
    s_mul_i32 s37, s37, 7168
    s_add_u32 s37, s37, 0
    buffer_load_dword v127, v6, s[16:19], s37 offen
    v_mfma_f32_32x32x16_bf16 v[56:71], v[28:31], v[20:23], v[56:71]
    ds_read_b128 v[28:31], v10 offset:20480
    v_mfma_f32_32x32x16_bf16 v[72:87], v[32:35], v[20:23], v[72:87]
    ds_read_b128 v[32:35], v10 offset:24576
    ds_read_b128 v[20:23], v13 offset:1024
    s_waitcnt lgkmcnt(3)
    v_mfma_f32_32x32x16_bf16 v[40:55], v[24:27], v[16:19], v[40:55]
    ds_read_b128 v[24:27], v10 offset:17408
    s_waitcnt lgkmcnt(3)
    v_mfma_f32_32x32x16_bf16 v[56:71], v[28:31], v[16:19], v[56:71]
    ds_read_b128 v[28:31], v10 offset:21504
    s_waitcnt lgkmcnt(3)
    v_mfma_f32_32x32x16_bf16 v[72:87], v[32:35], v[16:19], v[72:87]
    ds_read_b128 v[32:35], v10 offset:25600
    ds_read_b128 v[16:19], v13 offset:2048
    s_waitcnt lgkmcnt(3)
    v_mfma_f32_32x32x16_bf16 v[40:55], v[24:27], v[20:23], v[40:55]
    ds_read_b128 v[24:27], v10 offset:18432
    s_waitcnt lgkmcnt(3)
    v_mfma_f32_32x32x16_bf16 v[56:71], v[28:31], v[20:23], v[56:71]
    ds_read_b128 v[28:31], v10 offset:22528
    s_waitcnt lgkmcnt(3)
    v_mfma_f32_32x32x16_bf16 v[72:87], v[32:35], v[20:23], v[72:87]
    ds_read_b128 v[32:35], v10 offset:26624
    ds_read_b128 v[20:23], v13 offset:3072
    s_waitcnt lgkmcnt(3)
    v_mfma_f32_32x32x16_bf16 v[40:55], v[24:27], v[16:19], v[40:55]
    ds_read_b128 v[24:27], v10 offset:19456
    s_waitcnt lgkmcnt(3)
    v_mfma_f32_32x32x16_bf16 v[56:71], v[28:31], v[16:19], v[56:71]
    ds_read_b128 v[28:31], v10 offset:23552
    s_waitcnt lgkmcnt(3)
    v_mfma_f32_32x32x16_bf16 v[72:87], v[32:35], v[16:19], v[72:87]
    ds_read_b128 v[32:35], v10 offset:27648
    s_waitcnt vmcnt(1) lgkmcnt(0)
    s_barrier
    ds_read_b128 v[16:19], v13 offset:16384
    v_mfma_f32_32x32x16_bf16 v[40:55], v[24:27], v[20:23], v[40:55]
    ds_read_b128 v[24:27], v11 offset:16384
    v_mfma_f32_32x32x16_bf16 v[56:71], v[28:31], v[20:23], v[56:71]
    ds_read_b128 v[28:31], v11 offset:20480
    v_mfma_f32_32x32x16_bf16 v[72:87], v[32:35], v[20:23], v[72:87]
    ds_read_b128 v[32:35], v11 offset:24576
    ds_read_b128 v[20:23], v13 offset:17408
    s_waitcnt lgkmcnt(3)
    v_mfma_f32_32x32x16_bf16 v[40:55], v[24:27], v[16:19], v[40:55]
    ds_read_b128 v[24:27], v11 offset:17408
    s_waitcnt lgkmcnt(3)
    v_mfma_f32_32x32x16_bf16 v[56:71], v[28:31], v[16:19], v[56:71]
    ds_read_b128 v[28:31], v11 offset:21504
    s_waitcnt lgkmcnt(3)
    v_mfma_f32_32x32x16_bf16 v[72:87], v[32:35], v[16:19], v[72:87]
    ds_read_b128 v[32:35], v11 offset:25600
    ds_read_b128 v[16:19], v13 offset:18432
    s_waitcnt lgkmcnt(3)
    v_mfma_f32_32x32x16_bf16 v[40:55], v[24:27], v[20:23], v[40:55]
    ds_read_b128 v[24:27], v11 offset:18432
    s_waitcnt lgkmcnt(3)
    v_mfma_f32_32x32x16_bf16 v[56:71], v[28:31], v[20:23], v[56:71]
    ds_read_b128 v[28:31], v11 offset:22528
    s_waitcnt lgkmcnt(3)
    v_mfma_f32_32x32x16_bf16 v[72:87], v[32:35], v[20:23], v[72:87]
    ds_read_b128 v[32:35], v11 offset:26624
    ds_read_b128 v[20:23], v13 offset:19456
    s_waitcnt lgkmcnt(3)
    v_mfma_f32_32x32x16_bf16 v[40:55], v[24:27], v[16:19], v[40:55]
    ds_read_b128 v[24:27], v11 offset:19456
    s_waitcnt lgkmcnt(3)
    v_mfma_f32_32x32x16_bf16 v[56:71], v[28:31], v[16:19], v[56:71]
    ds_read_b128 v[28:31], v11 offset:23552
    s_waitcnt lgkmcnt(3)
    v_mfma_f32_32x32x16_bf16 v[72:87], v[32:35], v[16:19], v[72:87]
    ds_read_b128 v[32:35], v11 offset:27648
    s_waitcnt lgkmcnt(2)
    v_mfma_f32_32x32x16_bf16 v[40:55], v[24:27], v[20:23], v[40:55]
    s_waitcnt lgkmcnt(1)
    v_mfma_f32_32x32x16_bf16 v[56:71], v[28:31], v[20:23], v[56:71]
    s_waitcnt lgkmcnt(0)
    v_mfma_f32_32x32x16_bf16 v[72:87], v[32:35], v[20:23], v[72:87]
    s_waitcnt lgkmcnt(0)
    s_barrier
    s_lshl_b32 s48, s26, 11
    s_mul_i32 s36, s29, 114688
    s_mul_i32 s37, s28, 7168
    s_add_u32 s36, s36, s37
    s_add_u32 s36, s36, 12587008
    ds_read_b128 v[160:163], v14 offset:256
    ds_read_b128 v[164:167], v14 offset:288
    ds_read_b128 v[168:171], v14 offset:704
    ds_read_b128 v[172:175], v14 offset:736
    s_waitcnt lgkmcnt(0)
    ds_read_b128 v[176:179], v14 offset:320
    ds_read_b128 v[180:183], v14 offset:352
    ds_read_b128 v[184:187], v14 offset:768
    ds_read_b128 v[188:191], v14 offset:800
    v_pk_fma_f32 v[40:41], v[118:119], v[160:161], v[40:41]
    v_pk_fma_f32 v[42:43], v[118:119], v[162:163], v[42:43]
    v_pk_fma_f32 v[44:45], v[118:119], v[164:165], v[44:45]
    v_pk_fma_f32 v[46:47], v[118:119], v[166:167], v[46:47]
    v_pk_fma_f32 v[48:49], v[118:119], v[168:169], v[48:49]
    v_pk_fma_f32 v[50:51], v[118:119], v[170:171], v[50:51]
    v_pk_fma_f32 v[52:53], v[118:119], v[172:173], v[52:53]
    v_pk_fma_f32 v[54:55], v[118:119], v[174:175], v[54:55]
    v_pk_mul_f32 v[144:145], v[40:41], v[120:121]
    v_pk_mul_f32 v[146:147], v[42:43], v[120:121]
    v_pk_mul_f32 v[148:149], v[44:45], v[120:121]
    v_pk_mul_f32 v[150:151], v[46:47], v[120:121]
    v_exp_f32 v144, v144
    v_exp_f32 v145, v145
    v_exp_f32 v146, v146
    v_exp_f32 v147, v147
    v_exp_f32 v148, v148
    v_exp_f32 v149, v149
    v_exp_f32 v150, v150
    v_exp_f32 v151, v151
    v_pk_mul_f32 v[40:41], v[40:41], v[48:49]
    v_pk_mul_f32 v[42:43], v[42:43], v[50:51]
    v_pk_mul_f32 v[44:45], v[44:45], v[52:53]
    v_pk_mul_f32 v[46:47], v[46:47], v[54:55]
    v_pk_fma_f32 v[144:145], v[144:145], v[122:123], v[122:123]
    v_pk_fma_f32 v[146:147], v[146:147], v[122:123], v[122:123]
    v_pk_fma_f32 v[148:149], v[148:149], v[122:123], v[122:123]
    v_pk_fma_f32 v[150:151], v[150:151], v[122:123], v[122:123]
    v_rcp_f32 v144, v144
    v_rcp_f32 v145, v145
    v_rcp_f32 v146, v146
    v_rcp_f32 v147, v147
    v_rcp_f32 v148, v148
    v_rcp_f32 v149, v149
    v_rcp_f32 v150, v150
    v_rcp_f32 v151, v151
    v_pk_mul_f32 v[40:41], v[40:41], v[144:145]
    v_pk_mul_f32 v[42:43], v[42:43], v[146:147]
    v_pk_mul_f32 v[44:45], v[44:45], v[148:149]
    v_pk_mul_f32 v[46:47], v[46:47], v[150:151]
    v_cvt_pk_bf16_f32 v40, v40, v41
    v_cvt_pk_bf16_f32 v41, v42, v43
    v_cvt_pk_bf16_f32 v42, v44, v45
    v_cvt_pk_bf16_f32 v43, v46, v47
    buffer_store_dwordx4 v[40:43], v112, s[20:23], s36 offen offset:0 sc1
    s_waitcnt lgkmcnt(0)
    ds_read_b128 v[160:163], v14 offset:384
    ds_read_b128 v[164:167], v14 offset:416
    ds_read_b128 v[168:171], v14 offset:832
    ds_read_b128 v[172:175], v14 offset:864
    v_pk_fma_f32 v[56:57], v[118:119], v[176:177], v[56:57]
    v_pk_fma_f32 v[58:59], v[118:119], v[178:179], v[58:59]
    v_pk_fma_f32 v[60:61], v[118:119], v[180:181], v[60:61]
    v_pk_fma_f32 v[62:63], v[118:119], v[182:183], v[62:63]
    v_pk_fma_f32 v[64:65], v[118:119], v[184:185], v[64:65]
    v_pk_fma_f32 v[66:67], v[118:119], v[186:187], v[66:67]
    v_pk_fma_f32 v[68:69], v[118:119], v[188:189], v[68:69]
    v_pk_fma_f32 v[70:71], v[118:119], v[190:191], v[70:71]
    v_pk_mul_f32 v[144:145], v[56:57], v[120:121]
    v_pk_mul_f32 v[146:147], v[58:59], v[120:121]
    v_pk_mul_f32 v[148:149], v[60:61], v[120:121]
    v_pk_mul_f32 v[150:151], v[62:63], v[120:121]
    v_exp_f32 v144, v144
    v_exp_f32 v145, v145
    v_exp_f32 v146, v146
    v_exp_f32 v147, v147
    v_exp_f32 v148, v148
    v_exp_f32 v149, v149
    v_exp_f32 v150, v150
    v_exp_f32 v151, v151
    v_pk_mul_f32 v[56:57], v[56:57], v[64:65]
    v_pk_mul_f32 v[58:59], v[58:59], v[66:67]
    v_pk_mul_f32 v[60:61], v[60:61], v[68:69]
    v_pk_mul_f32 v[62:63], v[62:63], v[70:71]
    v_pk_fma_f32 v[144:145], v[144:145], v[122:123], v[122:123]
    v_pk_fma_f32 v[146:147], v[146:147], v[122:123], v[122:123]
    v_pk_fma_f32 v[148:149], v[148:149], v[122:123], v[122:123]
    v_pk_fma_f32 v[150:151], v[150:151], v[122:123], v[122:123]
    v_rcp_f32 v144, v144
    v_rcp_f32 v145, v145
    v_rcp_f32 v146, v146
    v_rcp_f32 v147, v147
    v_rcp_f32 v148, v148
    v_rcp_f32 v149, v149
    v_rcp_f32 v150, v150
    v_rcp_f32 v151, v151
    v_pk_mul_f32 v[56:57], v[56:57], v[144:145]
    v_pk_mul_f32 v[58:59], v[58:59], v[146:147]
    v_pk_mul_f32 v[60:61], v[60:61], v[148:149]
    v_pk_mul_f32 v[62:63], v[62:63], v[150:151]
    v_cvt_pk_bf16_f32 v56, v56, v57
    v_cvt_pk_bf16_f32 v57, v58, v59
    v_cvt_pk_bf16_f32 v58, v60, v61
    v_cvt_pk_bf16_f32 v59, v62, v63
    buffer_store_dwordx4 v[56:59], v112, s[20:23], s36 offen offset:1024 sc1
    s_waitcnt lgkmcnt(0)
    v_pk_fma_f32 v[72:73], v[118:119], v[160:161], v[72:73]
    v_pk_fma_f32 v[74:75], v[118:119], v[162:163], v[74:75]
    v_pk_fma_f32 v[76:77], v[118:119], v[164:165], v[76:77]
    v_pk_fma_f32 v[78:79], v[118:119], v[166:167], v[78:79]
    v_pk_fma_f32 v[80:81], v[118:119], v[168:169], v[80:81]
    v_pk_fma_f32 v[82:83], v[118:119], v[170:171], v[82:83]
    v_pk_fma_f32 v[84:85], v[118:119], v[172:173], v[84:85]
    v_pk_fma_f32 v[86:87], v[118:119], v[174:175], v[86:87]
    v_pk_mul_f32 v[144:145], v[72:73], v[120:121]
    v_pk_mul_f32 v[146:147], v[74:75], v[120:121]
    v_pk_mul_f32 v[148:149], v[76:77], v[120:121]
    v_pk_mul_f32 v[150:151], v[78:79], v[120:121]
    v_exp_f32 v144, v144
    v_exp_f32 v145, v145
    v_exp_f32 v146, v146
    v_exp_f32 v147, v147
    v_exp_f32 v148, v148
    v_exp_f32 v149, v149
    v_exp_f32 v150, v150
    v_exp_f32 v151, v151
    v_pk_mul_f32 v[72:73], v[72:73], v[80:81]
    v_pk_mul_f32 v[74:75], v[74:75], v[82:83]
    v_pk_mul_f32 v[76:77], v[76:77], v[84:85]
    v_pk_mul_f32 v[78:79], v[78:79], v[86:87]
    v_pk_fma_f32 v[144:145], v[144:145], v[122:123], v[122:123]
    v_pk_fma_f32 v[146:147], v[146:147], v[122:123], v[122:123]
    v_pk_fma_f32 v[148:149], v[148:149], v[122:123], v[122:123]
    v_pk_fma_f32 v[150:151], v[150:151], v[122:123], v[122:123]
    v_rcp_f32 v144, v144
    v_rcp_f32 v145, v145
    v_rcp_f32 v146, v146
    v_rcp_f32 v147, v147
    v_rcp_f32 v148, v148
    v_rcp_f32 v149, v149
    v_rcp_f32 v150, v150
    v_rcp_f32 v151, v151
    v_pk_mul_f32 v[72:73], v[72:73], v[144:145]
    v_pk_mul_f32 v[74:75], v[74:75], v[146:147]
    v_pk_mul_f32 v[76:77], v[76:77], v[148:149]
    v_pk_mul_f32 v[78:79], v[78:79], v[150:151]
    v_cvt_pk_bf16_f32 v72, v72, v73
    v_cvt_pk_bf16_f32 v73, v74, v75
    v_cvt_pk_bf16_f32 v74, v76, v77
    v_cvt_pk_bf16_f32 v75, v78, v79
    buffer_store_dwordx4 v[72:75], v112, s[20:23], s36 offen offset:2048 sc1
    s_lshl_b32 s45, s27, 8
    s_lshl_b32 s39, s28, 2
    s_add_u32 s45, s45, s39
    s_add_u32 s45, s45, 25171968
    s_and_b32 s27, s2, 7
    s_lshl_b32 s27, s27, 2
    s_lshr_b32 s28, s2, 3
    s_and_b32 s28, s28, 3
    s_add_u32 s27, s27, s28
    s_lshr_b32 s28, s2, 5
    s_and_b32 s29, s26, 1
    s_lshr_b32 s30, s26, 1
    s_lshl_b32 s31, s27, 1
    s_add_u32 s31, s31, s30
    s_lshl_b32 s34, s26, 11
    s_mul_i32 s32, s31, 114688
    s_lshl_b32 s33, s29, 11
    s_add_u32 s32, s32, s33
    s_add_u32 s32, s32, 12582912
    v_add_u32 v115, s34, v112
    v_add_u32 v116, 57344, v115
    s_mov_b32 s41, 0
    s_add_u32 m0, s48, 0
    s_nop 0
    buffer_load_dwordx4 v113, s[16:19], s41 offen lds
    buffer_load_dwordx4 v114, s[16:19], s41 offen offset:1024 lds
    s_mov_b32 s41, 65536
    s_add_u32 m0, s48, 8192
    s_nop 0
    buffer_load_dwordx4 v113, s[16:19], s41 offen lds
    buffer_load_dwordx4 v114, s[16:19], s41 offen offset:1024 lds
    s_mov_b32 s41, 131072
    s_add_u32 m0, s48, 16384
    s_nop 0
    buffer_load_dwordx4 v113, s[16:19], s41 offen lds
    buffer_load_dwordx4 v114, s[16:19], s41 offen offset:1024 lds
    s_mov_b32 s41, 196608
    s_add_u32 m0, s48, 24576
    s_nop 0
    buffer_load_dwordx4 v113, s[16:19], s41 offen lds
    buffer_load_dwordx4 v114, s[16:19], s41 offen offset:1024 lds
    s_waitcnt vmcnt(8)
    s_barrier
    s_mov_b32 s41, 262144
    s_add_u32 m0, s48, 32768
    s_nop 0
    buffer_load_dwordx4 v113, s[16:19], s41 offen lds
    buffer_load_dwordx4 v114, s[16:19], s41 offen offset:1024 lds
    s_mov_b32 s41, 327680
    s_add_u32 m0, s48, 40960
    s_nop 0
    buffer_load_dwordx4 v113, s[16:19], s41 offen lds
    buffer_load_dwordx4 v114, s[16:19], s41 offen offset:1024 lds
    s_mov_b32 s41, 393216
    s_add_u32 m0, s48, 49152
    s_nop 0
    buffer_load_dwordx4 v113, s[16:19], s41 offen lds
    buffer_load_dwordx4 v114, s[16:19], s41 offen offset:1024 lds
    s_mov_b32 s41, 458752
    s_add_u32 m0, s48, 57344
    s_nop 0
    buffer_load_dwordx4 v113, s[16:19], s41 offen lds
    buffer_load_dwordx4 v114, s[16:19], s41 offen offset:1024 lds
    s_mov_b32 s41, 524288
    s_add_u32 m0, s48, 65536
    s_nop 0
    buffer_load_dwordx4 v113, s[16:19], s41 offen lds
    buffer_load_dwordx4 v114, s[16:19], s41 offen offset:1024 lds
    s_mov_b32 s41, 589824
    s_add_u32 m0, s48, 73728
    s_nop 0
    buffer_load_dwordx4 v113, s[16:19], s41 offen lds
    buffer_load_dwordx4 v114, s[16:19], s41 offen offset:1024 lds
    s_mov_b32 s41, 655360
    s_add_u32 m0, s48, 81920
    s_nop 0
    buffer_load_dwordx4 v113, s[16:19], s41 offen lds
    buffer_load_dwordx4 v114, s[16:19], s41 offen offset:1024 lds
    s_mov_b32 s41, 720896
    s_add_u32 m0, s48, 90112
    s_nop 0
    buffer_load_dwordx4 v113, s[16:19], s41 offen lds
    buffer_load_dwordx4 v114, s[16:19], s41 offen offset:1024 lds
    v_min_u32 v5, 55, v1
    v_lshlrev_b32 v6, 7, v5
    s_lshr_b32 s37, s2, 3
    s_lshl_b32 s37, s37, 2
    s_add_u32 s37, s37, s26
    s_mul_i32 s37, s37, 7168
    s_add_u32 s37, s37, 917504
    buffer_load_dword v127, v6, s[16:19], s37 offen
    s_barrier
    s_add_u32 s40, s32, 0
    s_add_u32 m0, s34, 98304
    s_nop 0
    buffer_load_dwordx4 v112, s[20:23], s40 offen sc1 lds
    buffer_load_dwordx4 v112, s[20:23], s40 offen offset:1024 sc1 lds
    s_add_u32 s40, s32, 4096
    s_add_u32 m0, s34, 106496
    s_nop 0
    buffer_load_dwordx4 v112, s[20:23], s40 offen sc1 lds
    buffer_load_dwordx4 v112, s[20:23], s40 offen offset:1024 sc1 lds
    s_add_u32 s40, s32, 8192
    s_add_u32 m0, s34, 114688
    s_nop 0
    buffer_load_dwordx4 v112, s[20:23], s40 offen sc1 lds
    buffer_load_dwordx4 v112, s[20:23], s40 offen offset:1024 sc1 lds
    s_add_u32 s40, s32, 12288
    s_add_u32 m0, s34, 122880
    s_nop 0
    buffer_load_dwordx4 v112, s[20:23], s40 offen sc1 lds
    buffer_load_dwordx4 v112, s[20:23], s40 offen offset:1024 sc1 lds
    s_add_u32 s40, s32, 16384
    s_add_u32 m0, s34, 131072
    s_nop 0
    buffer_load_dwordx4 v112, s[20:23], s40 offen sc1 lds
    buffer_load_dwordx4 v112, s[20:23], s40 offen offset:1024 sc1 lds
    s_add_u32 s40, s32, 20480
    s_add_u32 m0, s34, 139264
    s_nop 0
    buffer_load_dwordx4 v112, s[20:23], s40 offen sc1 lds
    buffer_load_dwordx4 v112, s[20:23], s40 offen offset:1024 sc1 lds
    s_waitcnt vmcnt(10) lgkmcnt(0)
    s_barrier
    s_add_u32 s40, s32, 24576
    s_add_u32 m0, s34, 147456
    s_nop 0
    buffer_load_dwordx4 v112, s[20:23], s40 offen sc1 lds
    buffer_load_dwordx4 v112, s[20:23], s40 offen offset:1024 sc1 lds
    s_waitcnt vmcnt(10) lgkmcnt(0)
    s_barrier
    s_add_u32 s40, s32, 28672
    s_add_u32 m0, s34, 155648
    s_nop 0
    buffer_load_dwordx4 v112, s[20:23], s40 offen sc1 lds
    buffer_load_dwordx4 v112, s[20:23], s40 offen offset:1024 sc1 lds
    s_waitcnt vmcnt(10) lgkmcnt(0)
    s_barrier
    s_add_u32 s40, s32, 32768
    s_add_u32 m0, s34, 98304
    s_nop 0
    buffer_load_dwordx4 v112, s[20:23], s40 offen sc1 lds
    buffer_load_dwordx4 v112, s[20:23], s40 offen offset:1024 sc1 lds
    s_mov_b32 s41, 786432
    s_add_u32 m0, s48, 0
    s_nop 0
    buffer_load_dwordx4 v113, s[16:19], s41 offen lds
    buffer_load_dwordx4 v114, s[16:19], s41 offen offset:1024 lds
    s_waitcnt vmcnt(12) lgkmcnt(0)
    s_barrier
    s_add_u32 s40, s32, 36864
    s_add_u32 m0, s34, 106496
    s_nop 0
    buffer_load_dwordx4 v112, s[20:23], s40 offen sc1 lds
    buffer_load_dwordx4 v112, s[20:23], s40 offen offset:1024 sc1 lds
    s_mov_b32 s41, 851968
    s_add_u32 m0, s48, 8192
    s_nop 0
    buffer_load_dwordx4 v113, s[16:19], s41 offen lds
    buffer_load_dwordx4 v114, s[16:19], s41 offen offset:1024 lds
    s_waitcnt vmcnt(14) lgkmcnt(0)
    s_barrier
    s_add_u32 s40, s32, 40960
    s_add_u32 m0, s34, 114688
    s_nop 0
    buffer_load_dwordx4 v112, s[20:23], s40 offen sc1 lds
    buffer_load_dwordx4 v112, s[20:23], s40 offen offset:1024 sc1 lds
    s_mov_b32 s41, 917504
    s_add_u32 m0, s48, 16384
    s_nop 0
    buffer_load_dwordx4 v113, s[16:19], s41 offen lds
    buffer_load_dwordx4 v114, s[16:19], s41 offen offset:1024 lds
    s_waitcnt vmcnt(16) lgkmcnt(0)
    s_barrier
    s_add_u32 s40, s32, 45056
    s_add_u32 m0, s34, 122880
    s_nop 0
    buffer_load_dwordx4 v112, s[20:23], s40 offen sc1 lds
    buffer_load_dwordx4 v112, s[20:23], s40 offen offset:1024 sc1 lds
    s_mov_b32 s41, 983040
    s_add_u32 m0, s48, 24576
    s_nop 0
    buffer_load_dwordx4 v113, s[16:19], s41 offen lds
    buffer_load_dwordx4 v114, s[16:19], s41 offen offset:1024 lds
    s_waitcnt vmcnt(18) lgkmcnt(0)
    s_barrier
    s_add_u32 s40, s32, 49152
    s_add_u32 m0, s34, 131072
    s_nop 0
    buffer_load_dwordx4 v112, s[20:23], s40 offen sc1 lds
    buffer_load_dwordx4 v112, s[20:23], s40 offen offset:1024 sc1 lds
    s_mov_b32 s41, 1048576
    s_add_u32 m0, s48, 32768
    s_nop 0
    buffer_load_dwordx4 v113, s[16:19], s41 offen lds
    buffer_load_dwordx4 v114, s[16:19], s41 offen offset:1024 lds
    s_waitcnt vmcnt(20) lgkmcnt(0)
    s_barrier
    s_add_u32 s40, s32, 53248
    s_add_u32 m0, s34, 139264
    s_nop 0
    buffer_load_dwordx4 v112, s[20:23], s40 offen sc1 lds
    buffer_load_dwordx4 v112, s[20:23], s40 offen offset:1024 sc1 lds
    s_mov_b32 s41, 1114112
    s_add_u32 m0, s48, 40960
    s_nop 0
    buffer_load_dwordx4 v113, s[16:19], s41 offen lds
    buffer_load_dwordx4 v114, s[16:19], s41 offen offset:1024 lds
    s_waitcnt vmcnt(22) lgkmcnt(0)
    s_barrier
    s_add_u32 s40, s32, 57344
    s_add_u32 m0, s34, 147456
    s_nop 0
    buffer_load_dwordx4 v112, s[20:23], s40 offen sc1 lds
    buffer_load_dwordx4 v112, s[20:23], s40 offen offset:1024 sc1 lds
    s_mov_b32 s41, 1179648
    s_add_u32 m0, s48, 49152
    s_nop 0
    buffer_load_dwordx4 v113, s[16:19], s41 offen lds
    buffer_load_dwordx4 v114, s[16:19], s41 offen offset:1024 lds
    s_waitcnt vmcnt(22) lgkmcnt(0)
    s_barrier
    s_add_u32 s40, s32, 61440
    s_add_u32 m0, s34, 155648
    s_nop 0
    buffer_load_dwordx4 v112, s[20:23], s40 offen sc1 lds
    buffer_load_dwordx4 v112, s[20:23], s40 offen offset:1024 sc1 lds
    s_mov_b32 s41, 1245184
    s_add_u32 m0, s48, 57344
    s_nop 0
    buffer_load_dwordx4 v113, s[16:19], s41 offen lds
    buffer_load_dwordx4 v114, s[16:19], s41 offen offset:1024 lds
    s_waitcnt vmcnt(22) lgkmcnt(0)
    s_barrier
    s_add_u32 s40, s32, 65536
    s_add_u32 m0, s34, 98304
    s_nop 0
    buffer_load_dwordx4 v112, s[20:23], s40 offen sc1 lds
    buffer_load_dwordx4 v112, s[20:23], s40 offen offset:1024 sc1 lds
    s_mov_b32 s41, 1310720
    s_add_u32 m0, s48, 65536
    s_nop 0
    buffer_load_dwordx4 v113, s[16:19], s41 offen lds
    buffer_load_dwordx4 v114, s[16:19], s41 offen offset:1024 lds
    s_waitcnt vmcnt(22) lgkmcnt(0)
    s_barrier
    s_add_u32 s40, s32, 69632
    s_add_u32 m0, s34, 106496
    s_nop 0
    buffer_load_dwordx4 v112, s[20:23], s40 offen sc1 lds
    buffer_load_dwordx4 v112, s[20:23], s40 offen offset:1024 sc1 lds
    s_mov_b32 s41, 1376256
    s_add_u32 m0, s48, 73728
    s_nop 0
    buffer_load_dwordx4 v113, s[16:19], s41 offen lds
    buffer_load_dwordx4 v114, s[16:19], s41 offen offset:1024 lds
    s_waitcnt vmcnt(22) lgkmcnt(0)
    s_barrier
    s_add_u32 s40, s32, 73728
    s_add_u32 m0, s34, 114688
    s_nop 0
    buffer_load_dwordx4 v112, s[20:23], s40 offen sc1 lds
    buffer_load_dwordx4 v112, s[20:23], s40 offen offset:1024 sc1 lds
    s_mov_b32 s41, 1441792
    s_add_u32 m0, s48, 81920
    s_nop 0
    buffer_load_dwordx4 v113, s[16:19], s41 offen lds
    buffer_load_dwordx4 v114, s[16:19], s41 offen offset:1024 lds
    s_waitcnt vmcnt(22) lgkmcnt(0)
    s_barrier
    s_add_u32 s40, s32, 77824
    s_add_u32 m0, s34, 122880
    s_nop 0
    buffer_load_dwordx4 v112, s[20:23], s40 offen sc1 lds
    buffer_load_dwordx4 v112, s[20:23], s40 offen offset:1024 sc1 lds
    s_mov_b32 s41, 1507328
    s_add_u32 m0, s48, 90112
    s_nop 0
    buffer_load_dwordx4 v113, s[16:19], s41 offen lds
    buffer_load_dwordx4 v114, s[16:19], s41 offen offset:1024 lds
    s_waitcnt vmcnt(22) lgkmcnt(0)
    s_barrier
    s_add_u32 s40, s32, 81920
    s_add_u32 m0, s34, 131072
    s_nop 0
    buffer_load_dwordx4 v112, s[20:23], s40 offen sc1 lds
    buffer_load_dwordx4 v112, s[20:23], s40 offen offset:1024 sc1 lds
    s_mov_b32 s41, 1572864
    s_add_u32 m0, s48, 0
    s_nop 0
    buffer_load_dwordx4 v113, s[16:19], s41 offen lds
    buffer_load_dwordx4 v114, s[16:19], s41 offen offset:1024 lds
    s_waitcnt vmcnt(22) lgkmcnt(0)
    s_barrier
    s_add_u32 s40, s32, 86016
    s_add_u32 m0, s34, 139264
    s_nop 0
    buffer_load_dwordx4 v112, s[20:23], s40 offen sc1 lds
    buffer_load_dwordx4 v112, s[20:23], s40 offen offset:1024 sc1 lds
    s_mov_b32 s41, 1638400
    s_add_u32 m0, s48, 8192
    s_nop 0
    buffer_load_dwordx4 v113, s[16:19], s41 offen lds
    buffer_load_dwordx4 v114, s[16:19], s41 offen offset:1024 lds
    s_waitcnt vmcnt(22) lgkmcnt(0)
    s_barrier
    s_add_u32 s40, s32, 90112
    s_add_u32 m0, s34, 147456
    s_nop 0
    buffer_load_dwordx4 v112, s[20:23], s40 offen sc1 lds
    buffer_load_dwordx4 v112, s[20:23], s40 offen offset:1024 sc1 lds
    s_mov_b32 s41, 1703936
    s_add_u32 m0, s48, 16384
    s_nop 0
    buffer_load_dwordx4 v113, s[16:19], s41 offen lds
    buffer_load_dwordx4 v114, s[16:19], s41 offen offset:1024 lds
    s_waitcnt vmcnt(22) lgkmcnt(0)
    s_barrier
    s_add_u32 s40, s32, 94208
    s_add_u32 m0, s34, 155648
    s_nop 0
    buffer_load_dwordx4 v112, s[20:23], s40 offen sc1 lds
    buffer_load_dwordx4 v112, s[20:23], s40 offen offset:1024 sc1 lds
    s_mov_b32 s41, 1769472
    s_add_u32 m0, s48, 24576
    s_nop 0
    buffer_load_dwordx4 v113, s[16:19], s41 offen lds
    buffer_load_dwordx4 v114, s[16:19], s41 offen offset:1024 lds
    s_waitcnt vmcnt(22) lgkmcnt(0)
    s_barrier
    s_add_u32 s40, s32, 98304
    s_add_u32 m0, s34, 98304
    s_nop 0
    buffer_load_dwordx4 v112, s[20:23], s40 offen sc1 lds
    buffer_load_dwordx4 v112, s[20:23], s40 offen offset:1024 sc1 lds
    s_waitcnt vmcnt(20) lgkmcnt(0)
    s_barrier
    s_add_u32 s40, s32, 102400
    s_add_u32 m0, s34, 106496
    s_nop 0
    buffer_load_dwordx4 v112, s[20:23], s40 offen sc1 lds
    buffer_load_dwordx4 v112, s[20:23], s40 offen offset:1024 sc1 lds
    s_waitcnt vmcnt(18) lgkmcnt(0)
    s_barrier
    s_add_u32 s40, s32, 106496
    s_add_u32 m0, s34, 114688
    s_nop 0
    buffer_load_dwordx4 v112, s[20:23], s40 offen sc1 lds
    buffer_load_dwordx4 v112, s[20:23], s40 offen offset:1024 sc1 lds
    s_waitcnt vmcnt(16) lgkmcnt(0)
    s_barrier
    s_add_u32 s40, s32, 110592
    s_add_u32 m0, s34, 122880
    s_nop 0
    buffer_load_dwordx4 v112, s[20:23], s40 offen sc1 lds
    buffer_load_dwordx4 v112, s[20:23], s40 offen offset:1024 sc1 lds
    s_waitcnt vmcnt(14) lgkmcnt(0)
    s_barrier
    s_waitcnt vmcnt(10) lgkmcnt(0)
    s_barrier
    s_waitcnt vmcnt(6) lgkmcnt(0)
    s_barrier
    s_waitcnt vmcnt(4) lgkmcnt(0)
    s_barrier
    s_waitcnt vmcnt(2) lgkmcnt(0)
    s_barrier
    s_waitcnt vmcnt(0) lgkmcnt(0)
    s_barrier
    s_endpgm
L_p3C:
    v_and_b32 v2, 31, v1
    v_lshrrev_b32 v3, 5, v1
    s_lshl_b32 s37, s28, 1
    s_add_u32 s37, s37, s29
    s_lshl_b32 s40, s30, 12
    s_add_u32 s40, s40, 65536
    v_add_u32 v12, s40, v112
    v_bfe_u32 v4, v1, 2, 2
    v_lshl_add_u32 v5, v3, 2, v4
    v_lshlrev_b32 v5, 7, v5
    v_lshrrev_b32 v4, 1, v4
    v_xor_b32 v4, s29, v4
    v_lshl_add_u32 v5, v4, 6, v5
    v_bfe_u32 v4, v1, 4, 1
    v_lshl_add_u32 v5, v4, 5, v5
    v_and_b32 v4, 3, v1
    v_lshl_add_u32 v113, v4, 3, v5
    s_lshl_b32 s38, s30, 12
    s_lshl_b32 s39, s29, 2
    v_and_b32 v4, 7, v2
    v_xor_b32 v4, s39, v4
    v_lshlrev_b32 v5, 7, v2
    v_lshl_add_u32 v5, v3, 3, v5
    v_add_u32 v5, s38, v5
    v_add_u32 v5, 131072, v5
    v_xor_b32 v80, 0, v4
    v_lshl_add_u32 v80, v80, 4, v5
    v_xor_b32 v81, 1, v4
    v_lshl_add_u32 v81, v81, 4, v5
    v_xor_b32 v82, 2, v4
    v_lshl_add_u32 v82, v82, 4, v5
    v_xor_b32 v83, 3, v4
    v_lshl_add_u32 v83, v83, 4, v5
    s_cmp_lg_u32 s25, 1
    s_cbranch_scc1 L_p3_w
    v_cmp_gt_u32 vcc, 8, v1
    v_lshlrev_b32 v7, 8, v1
    v_add_u32 v7, 10240, v7
    s_and_b32 s36, s2, 7
    s_lshl_b32 s36, s36, 8
    v_mov_b32 v8, s36
    v_cndmask_b32 v7, v8, v7, vcc
    v_mov_b32 v8, 32
    v_mov_b32 v9, 128
    v_cndmask_b32 v8, v8, v9, vcc
    s_mov_b32 s46, 25165824
    s_mov_b32 s47, 0
L_poll7:
    s_sleep 12
    buffer_load_dword v6, v7, s[20:23], s46 offen sc1
    s_add_u32 s47, s47, 1
    s_waitcnt vmcnt(0)
    v_cmp_gt_u32 vcc, v8, v6
    s_cmp_gt_u32 s47, 262144
    s_cbranch_scc1 L_poll7_out
    s_cbranch_vccnz L_poll7
L_poll7_out:
L_p3_w:
    s_barrier
    s_barrier
    s_waitcnt lgkmcnt(0)
    ds_read_b128 v[120:123], v12 offset:0
    ds_read_b64_tr_b16 v[124:125], v113 offset:0
    ds_read_b64_tr_b16 v[126:127], v113 offset:1024
    ds_read_b128 v[128:131], v12 offset:1024
    ds_read_b64_tr_b16 v[132:133], v113 offset:2048
    ds_read_b64_tr_b16 v[134:135], v113 offset:3072
    ds_read_b128 v[136:139], v12 offset:2048
    ds_read_b64_tr_b16 v[140:141], v113 offset:4096
    ds_read_b64_tr_b16 v[142:143], v113 offset:5120
    ds_read_b128 v[144:147], v12 offset:3072
    ds_read_b64_tr_b16 v[148:149], v113 offset:6144
    ds_read_b64_tr_b16 v[150:151], v113 offset:7168
    s_barrier
    ds_read_b128 v[152:155], v12 offset:8192
    ds_read_b64_tr_b16 v[156:157], v113 offset:8192
    ds_read_b64_tr_b16 v[158:159], v113 offset:9216
    s_waitcnt lgkmcnt(12)
    v_mfma_f32_32x32x16_bf16 v[64:79], v[124:127], v[120:123], 0
    ds_read_b128 v[120:123], v12 offset:9216
    ds_read_b64_tr_b16 v[124:125], v113 offset:10240
    ds_read_b64_tr_b16 v[126:127], v113 offset:11264
    s_waitcnt lgkmcnt(12)
    v_mfma_f32_32x32x16_bf16 v[64:79], v[132:135], v[128:131], v[64:79]
    ds_read_b128 v[128:131], v12 offset:10240
    ds_read_b64_tr_b16 v[132:133], v113 offset:12288
    ds_read_b64_tr_b16 v[134:135], v113 offset:13312
    s_waitcnt lgkmcnt(12)
    v_mfma_f32_32x32x16_bf16 v[64:79], v[140:143], v[136:139], v[64:79]
    ds_read_b128 v[136:139], v12 offset:11264
    ds_read_b64_tr_b16 v[140:141], v113 offset:14336
    ds_read_b64_tr_b16 v[142:143], v113 offset:15360
    s_waitcnt lgkmcnt(12)
    v_mfma_f32_32x32x16_bf16 v[64:79], v[148:151], v[144:147], v[64:79]
    s_barrier
    ds_read_b128 v[144:147], v12 offset:16384
    ds_read_b64_tr_b16 v[148:149], v113 offset:16384
    ds_read_b64_tr_b16 v[150:151], v113 offset:17408
    s_waitcnt lgkmcnt(12)
    v_mfma_f32_32x32x16_bf16 v[64:79], v[156:159], v[152:155], v[64:79]
    ds_read_b128 v[152:155], v12 offset:17408
    ds_read_b64_tr_b16 v[156:157], v113 offset:18432
    ds_read_b64_tr_b16 v[158:159], v113 offset:19456
    s_waitcnt lgkmcnt(12)
    v_mfma_f32_32x32x16_bf16 v[64:79], v[124:127], v[120:123], v[64:79]
    ds_read_b128 v[120:123], v12 offset:18432
    ds_read_b64_tr_b16 v[124:125], v113 offset:20480
    ds_read_b64_tr_b16 v[126:127], v113 offset:21504
    s_waitcnt lgkmcnt(12)
    v_mfma_f32_32x32x16_bf16 v[64:79], v[132:135], v[128:131], v[64:79]
    ds_read_b128 v[128:131], v12 offset:19456
    ds_read_b64_tr_b16 v[132:133], v113 offset:22528
    ds_read_b64_tr_b16 v[134:135], v113 offset:23552
    s_waitcnt lgkmcnt(12)
    v_mfma_f32_32x32x16_bf16 v[64:79], v[140:143], v[136:139], v[64:79]
    s_barrier
    ds_read_b128 v[136:139], v12 offset:24576
    ds_read_b64_tr_b16 v[140:141], v113 offset:24576
    ds_read_b64_tr_b16 v[142:143], v113 offset:25600
    s_waitcnt lgkmcnt(12)
    v_mfma_f32_32x32x16_bf16 v[64:79], v[148:151], v[144:147], v[64:79]
    ds_read_b128 v[144:147], v12 offset:25600
    ds_read_b64_tr_b16 v[148:149], v113 offset:26624
    ds_read_b64_tr_b16 v[150:151], v113 offset:27648
    s_waitcnt lgkmcnt(12)
    v_mfma_f32_32x32x16_bf16 v[64:79], v[156:159], v[152:155], v[64:79]
    ds_read_b128 v[152:155], v12 offset:26624
    ds_read_b64_tr_b16 v[156:157], v113 offset:28672
    ds_read_b64_tr_b16 v[158:159], v113 offset:29696
    s_waitcnt lgkmcnt(12)
    v_mfma_f32_32x32x16_bf16 v[64:79], v[124:127], v[120:123], v[64:79]
    ds_read_b128 v[120:123], v12 offset:27648
    ds_read_b64_tr_b16 v[124:125], v113 offset:30720
    ds_read_b64_tr_b16 v[126:127], v113 offset:31744
    s_waitcnt lgkmcnt(12)
    v_mfma_f32_32x32x16_bf16 v[64:79], v[132:135], v[128:131], v[64:79]
    s_barrier
    ds_read_b128 v[128:131], v12 offset:32768
    ds_read_b64_tr_b16 v[132:133], v113 offset:32768
    ds_read_b64_tr_b16 v[134:135], v113 offset:33792
    s_waitcnt lgkmcnt(12)
    v_mfma_f32_32x32x16_bf16 v[64:79], v[140:143], v[136:139], v[64:79]
    ds_read_b128 v[136:139], v12 offset:33792
    ds_read_b64_tr_b16 v[140:141], v113 offset:34816
    ds_read_b64_tr_b16 v[142:143], v113 offset:35840
    s_waitcnt lgkmcnt(12)
    v_mfma_f32_32x32x16_bf16 v[64:79], v[148:151], v[144:147], v[64:79]
    ds_read_b128 v[144:147], v12 offset:34816
    ds_read_b64_tr_b16 v[148:149], v113 offset:36864
    ds_read_b64_tr_b16 v[150:151], v113 offset:37888
    s_waitcnt lgkmcnt(12)
    v_mfma_f32_32x32x16_bf16 v[64:79], v[156:159], v[152:155], v[64:79]
    ds_read_b128 v[152:155], v12 offset:35840
    ds_read_b64_tr_b16 v[156:157], v113 offset:38912
    ds_read_b64_tr_b16 v[158:159], v113 offset:39936
    s_waitcnt lgkmcnt(12)
    v_mfma_f32_32x32x16_bf16 v[64:79], v[124:127], v[120:123], v[64:79]
    s_barrier
    ds_read_b128 v[120:123], v12 offset:40960
    ds_read_b64_tr_b16 v[124:125], v113 offset:40960
    ds_read_b64_tr_b16 v[126:127], v113 offset:41984
    s_waitcnt lgkmcnt(12)
    v_mfma_f32_32x32x16_bf16 v[64:79], v[132:135], v[128:131], v[64:79]
    ds_read_b128 v[128:131], v12 offset:41984
    ds_read_b64_tr_b16 v[132:133], v113 offset:43008
    ds_read_b64_tr_b16 v[134:135], v113 offset:44032
    s_waitcnt lgkmcnt(12)
    v_mfma_f32_32x32x16_bf16 v[64:79], v[140:143], v[136:139], v[64:79]
    ds_read_b128 v[136:139], v12 offset:43008
    ds_read_b64_tr_b16 v[140:141], v113 offset:45056
    ds_read_b64_tr_b16 v[142:143], v113 offset:46080
    s_waitcnt lgkmcnt(12)
    v_mfma_f32_32x32x16_bf16 v[64:79], v[148:151], v[144:147], v[64:79]
    ds_read_b128 v[144:147], v12 offset:44032
    ds_read_b64_tr_b16 v[148:149], v113 offset:47104
    ds_read_b64_tr_b16 v[150:151], v113 offset:48128
    s_waitcnt lgkmcnt(12)
    v_mfma_f32_32x32x16_bf16 v[64:79], v[156:159], v[152:155], v[64:79]
    s_barrier
    ds_read_b128 v[152:155], v12 offset:49152
    ds_read_b64_tr_b16 v[156:157], v113 offset:49152
    ds_read_b64_tr_b16 v[158:159], v113 offset:50176
    s_waitcnt lgkmcnt(12)
    v_mfma_f32_32x32x16_bf16 v[64:79], v[124:127], v[120:123], v[64:79]
    ds_read_b128 v[120:123], v12 offset:50176
    ds_read_b64_tr_b16 v[124:125], v113 offset:51200
    ds_read_b64_tr_b16 v[126:127], v113 offset:52224
    s_waitcnt lgkmcnt(12)
    v_mfma_f32_32x32x16_bf16 v[64:79], v[132:135], v[128:131], v[64:79]
    ds_read_b128 v[128:131], v12 offset:51200
    ds_read_b64_tr_b16 v[132:133], v113 offset:53248
    ds_read_b64_tr_b16 v[134:135], v113 offset:54272
    s_waitcnt lgkmcnt(12)
    v_mfma_f32_32x32x16_bf16 v[64:79], v[140:143], v[136:139], v[64:79]
    ds_read_b128 v[136:139], v12 offset:52224
    ds_read_b64_tr_b16 v[140:141], v113 offset:55296
    ds_read_b64_tr_b16 v[142:143], v113 offset:56320
    s_waitcnt lgkmcnt(12)
    v_mfma_f32_32x32x16_bf16 v[64:79], v[148:151], v[144:147], v[64:79]
    s_barrier
    ds_read_b128 v[144:147], v12 offset:57344
    ds_read_b64_tr_b16 v[148:149], v113 offset:57344
    ds_read_b64_tr_b16 v[150:151], v113 offset:58368
    s_waitcnt lgkmcnt(12)
    v_mfma_f32_32x32x16_bf16 v[64:79], v[156:159], v[152:155], v[64:79]
    ds_read_b128 v[152:155], v12 offset:58368
    ds_read_b64_tr_b16 v[156:157], v113 offset:59392
    ds_read_b64_tr_b16 v[158:159], v113 offset:60416
    s_waitcnt lgkmcnt(12)
    v_mfma_f32_32x32x16_bf16 v[64:79], v[124:127], v[120:123], v[64:79]
    ds_read_b128 v[120:123], v12 offset:59392
    ds_read_b64_tr_b16 v[124:125], v113 offset:61440
    ds_read_b64_tr_b16 v[126:127], v113 offset:62464
    s_waitcnt lgkmcnt(12)
    v_mfma_f32_32x32x16_bf16 v[64:79], v[132:135], v[128:131], v[64:79]
    ds_read_b128 v[128:131], v12 offset:60416
    ds_read_b64_tr_b16 v[132:133], v113 offset:63488
    ds_read_b64_tr_b16 v[134:135], v113 offset:64512
    s_waitcnt lgkmcnt(12)
    v_mfma_f32_32x32x16_bf16 v[64:79], v[140:143], v[136:139], v[64:79]
    s_waitcnt lgkmcnt(9)
    v_mfma_f32_32x32x16_bf16 v[64:79], v[148:151], v[144:147], v[64:79]
    s_waitcnt lgkmcnt(6)
    v_mfma_f32_32x32x16_bf16 v[64:79], v[156:159], v[152:155], v[64:79]
    ds_read_b64 v[20:21], v80
    ds_read_b64 v[22:23], v81
    ds_read_b64 v[24:25], v82
    ds_read_b64 v[26:27], v83
    s_waitcnt lgkmcnt(7)
    v_mfma_f32_32x32x16_bf16 v[64:79], v[124:127], v[120:123], v[64:79]
    s_waitcnt lgkmcnt(4)
    v_mfma_f32_32x32x16_bf16 v[64:79], v[132:135], v[128:131], v[64:79]
    s_waitcnt lgkmcnt(0)
    s_barrier
    v_lshlrev_b32 v80, 16, v20
    v_and_b32 v81, 0xffff0000, v20
    v_lshlrev_b32 v82, 16, v21
    v_and_b32 v83, 0xffff0000, v21
    v_lshlrev_b32 v84, 16, v22
    v_and_b32 v85, 0xffff0000, v22
    v_lshlrev_b32 v86, 16, v23
    v_and_b32 v87, 0xffff0000, v23
    v_lshlrev_b32 v88, 16, v24
    v_and_b32 v89, 0xffff0000, v24
    v_lshlrev_b32 v90, 16, v25
    v_and_b32 v91, 0xffff0000, v25
    v_lshlrev_b32 v92, 16, v26
    v_and_b32 v93, 0xffff0000, v26
    v_lshlrev_b32 v94, 16, v27
    v_and_b32 v95, 0xffff0000, v27
    v_pk_add_f32 v[64:65], v[64:65], v[80:81]
    v_pk_add_f32 v[66:67], v[66:67], v[82:83]
    v_pk_add_f32 v[68:69], v[68:69], v[84:85]
    v_pk_add_f32 v[70:71], v[70:71], v[86:87]
    v_pk_add_f32 v[72:73], v[72:73], v[88:89]
    v_pk_add_f32 v[74:75], v[74:75], v[90:91]
    v_pk_add_f32 v[76:77], v[76:77], v[92:93]
    v_pk_add_f32 v[78:79], v[78:79], v[94:95]
    v_cvt_pk_bf16_f32 v104, v64, v65
    v_cvt_pk_bf16_f32 v105, v66, v67
    v_cvt_pk_bf16_f32 v106, v68, v69
    v_cvt_pk_bf16_f32 v107, v70, v71
    v_cvt_pk_bf16_f32 v108, v72, v73
    v_cvt_pk_bf16_f32 v109, v74, v75
    v_cvt_pk_bf16_f32 v110, v76, v77
    v_cvt_pk_bf16_f32 v111, v78, v79
    s_lshl_b32 s38, s31, 15
    s_lshl_b32 s39, s37, 11
    s_add_u32 s38, s38, s39
    s_add_u32 s38, s38, 8388608
    buffer_store_dwordx4 v[104:107], v112, s[20:23], s38 offen sc1
    buffer_store_dwordx4 v[108:111], v112, s[20:23], s38 offen offset:1024 sc1
    v_pk_add_f32 v[80:81], v[64:65], v[66:67]
    v_pk_mul_f32 v[82:83], v[64:65], v[64:65]
    v_pk_fma_f32 v[82:83], v[66:67], v[66:67], v[82:83]
    v_pk_add_f32 v[80:81], v[80:81], v[68:69]
    v_pk_fma_f32 v[82:83], v[68:69], v[68:69], v[82:83]
    v_pk_add_f32 v[80:81], v[80:81], v[70:71]
    v_pk_fma_f32 v[82:83], v[70:71], v[70:71], v[82:83]
    v_pk_add_f32 v[80:81], v[80:81], v[72:73]
    v_pk_fma_f32 v[82:83], v[72:73], v[72:73], v[82:83]
    v_pk_add_f32 v[80:81], v[80:81], v[74:75]
    v_pk_fma_f32 v[82:83], v[74:75], v[74:75], v[82:83]
    v_pk_add_f32 v[80:81], v[80:81], v[76:77]
    v_pk_fma_f32 v[82:83], v[76:77], v[76:77], v[82:83]
    v_pk_add_f32 v[80:81], v[80:81], v[78:79]
    v_pk_fma_f32 v[82:83], v[78:79], v[78:79], v[82:83]
    v_add_f32 v80, v80, v81
    v_add_f32 v81, v82, v83
    v_mov_b32 v82, v80
    v_mov_b32 v83, v81
    s_nop 0
    v_permlane32_swap_b32 v80, v82
    v_permlane32_swap_b32 v81, v83
    v_add_f32 v80, v80, v82
    v_add_f32 v81, v81, v83
    v_lshlrev_b32 v4, 3, v2
    s_lshl_b32 s38, s31, 12
    s_lshl_b32 s39, s37, 8
    s_add_u32 s38, s38, s39
    s_add_u32 s38, s38, 10485760
    s_mov_b64 exec, 0xffffffff
    buffer_store_dwordx2 v[80:81], v4, s[20:23], s38 offen sc1
    s_mov_b64 exec, -1
    s_lshr_b32 s45, s27, 1
    s_lshl_b32 s45, s45, 8
    s_and_b32 s39, s27, 1
    s_lshl_b32 s39, s39, 3
    s_add_u32 s39, s39, s28
    s_lshl_b32 s39, s39, 2
    s_add_u32 s45, s45, s39
    s_add_u32 s45, s45, 25167872
    s_and_b32 s27, s2, 7
    s_lshl_b32 s27, s27, 1
    s_lshr_b32 s28, s2, 3
    s_and_b32 s28, s28, 1
    s_add_u32 s27, s27, s28
    s_lshr_b32 s28, s2, 4
    s_lshl_b32 s29, s27, 2
    s_add_u32 s29, s29, s26
    s_lshl_b32 s38, s29, 15
    s_add_u32 s38, s38, 8388608
    s_lshl_b32 s40, s26, 12
    s_add_u32 s40, s40, 86016
    s_cmp_lt_u32 s25, 4
    s_cselect_b32 s31, 2, 5
    s_cselect_b32 s35, 20, 0
    s_mul_i32 s31, s31, s26
    s_add_u32 s31, s31, s35
    s_lshl_b32 s34, s31, 10
    s_mul_i32 s32, s28, 229376
    s_add_u32 s32, s32, 20971520
    s_waitcnt vmcnt(0)
    s_barrier
    s_cmp_lg_u32 s25, 0
    s_cbranch_scc1 L_sig8
    v_mov_b32 v4, 0
    v_mov_b32 v5, 1
    s_mov_b64 exec, 1
    s_cmp_eq_u32 s24, 0
    s_cbranch_scc1 L_msg9
    buffer_store_dword v5, v4, s[20:23], s45 offen
    s_branch L_mse10
L_msg9:
    buffer_store_dword v5, v4, s[20:23], s45 offen sc1
L_mse10:
    s_mov_b64 exec, -1
L_sig8:
    s_lshl_b32 s36, s27, 8
    s_add_u32 s36, s36, 2048
    s_cmp_lg_u32 s25, 1
    s_cbranch_scc1 L_wp11
    v_and_b32 v7, 15, v1
    v_lshlrev_b32 v7, 2, v7
    v_add_u32 v7, s36, v7
    v_mov_b32 v8, 1
    s_mov_b32 s46, 25165824
    s_mov_b32 s47, 0
L_poll12:
    buffer_load_dword v6, v7, s[20:23], s46 offen sc1
    s_add_u32 s47, s47, 1
    s_waitcnt vmcnt(0)
    v_cmp_gt_u32 vcc, v8, v6
    s_cmp_gt_u32 s47, 262144
    s_cbranch_scc1 L_poll12_out
    s_cbranch_vccnz L_poll12
L_poll12_out:
L_wp11:
    s_barrier
    s_add_u32 s39, s38, 0
    s_add_u32 m0, s40, 0
    s_nop 0
    buffer_load_dwordx4 v112, s[20:23], s39 offen offset:0 sc1 lds
    buffer_load_dwordx4 v112, s[20:23], s39 offen offset:1024 sc1 lds
    buffer_load_dwordx4 v112, s[20:23], s39 offen offset:2048 sc1 lds
    buffer_load_dwordx4 v112, s[20:23], s39 offen offset:3072 sc1 lds
    s_add_u32 s39, s38, 4096
    s_add_u32 m0, s40, 16384
    s_nop 0
    buffer_load_dwordx4 v112, s[20:23], s39 offen offset:0 sc1 lds
    buffer_load_dwordx4 v112, s[20:23], s39 offen offset:1024 sc1 lds
    buffer_load_dwordx4 v112, s[20:23], s39 offen offset:2048 sc1 lds
    buffer_load_dwordx4 v112, s[20:23], s39 offen offset:3072 sc1 lds
    s_add_u32 s39, s38, 8192
    s_add_u32 m0, s40, 32768
    s_nop 0
    buffer_load_dwordx4 v112, s[20:23], s39 offen offset:0 sc1 lds
    buffer_load_dwordx4 v112, s[20:23], s39 offen offset:1024 sc1 lds
    buffer_load_dwordx4 v112, s[20:23], s39 offen offset:2048 sc1 lds
    buffer_load_dwordx4 v112, s[20:23], s39 offen offset:3072 sc1 lds
    s_add_u32 s35, s31, 0
    s_lshr_b32 s36, s35, 2
    s_lshl_b32 s36, s36, 15
    s_and_b32 s35, s35, 3
    s_lshl_b32 s35, s35, 10
    s_add_u32 s35, s35, s36
    v_add_u32 v124, s35, v112
    s_add_u32 s35, s31, 1
    s_lshr_b32 s36, s35, 2
    s_lshl_b32 s36, s36, 15
    s_and_b32 s35, s35, 3
    s_lshl_b32 s35, s35, 10
    s_add_u32 s35, s35, s36
    v_add_u32 v125, s35, v112
    v_lshrrev_b32 v3, 5, v1
    v_mov_b32 v10, v112
    v_add_u32 v11, 28672, v10
    v_add_u32 v12, 57344, v10
    v_add_u32 v13, s40, v112
    v_lshlrev_b32 v14, 4, v3
    v_add_u32 v14, 135168, v14
    s_waitcnt vmcnt(8) lgkmcnt(0)
    s_barrier
    ds_read_b128 v[16:19], v13 offset:0
    ds_read_b128 v[24:27], v10 offset:0
    ds_read_b128 v[28:31], v10 offset:4096
    ds_read_b128 v[32:35], v10 offset:8192
    ds_read_b128 v[36:39], v10 offset:12288
    ds_read_b128 v[20:23], v13 offset:1024
    s_waitcnt lgkmcnt(4)
    v_mfma_f32_32x32x16_bf16 v[40:55], v[24:27], v[16:19], 0
    ds_read_b128 v[24:27], v10 offset:1024
    s_waitcnt lgkmcnt(4)
    v_mfma_f32_32x32x16_bf16 v[56:71], v[28:31], v[16:19], 0
    ds_read_b128 v[28:31], v10 offset:5120
    s_waitcnt lgkmcnt(4)
    v_mfma_f32_32x32x16_bf16 v[72:87], v[32:35], v[16:19], 0
    ds_read_b128 v[32:35], v10 offset:9216
    s_waitcnt lgkmcnt(4)
    v_mfma_f32_32x32x16_bf16 v[88:103], v[36:39], v[16:19], 0
    ds_read_b128 v[36:39], v10 offset:13312
    ds_read_b128 v[16:19], v13 offset:2048
    s_waitcnt lgkmcnt(4)
    v_mfma_f32_32x32x16_bf16 v[40:55], v[24:27], v[20:23], v[40:55]
    ds_read_b128 v[24:27], v10 offset:2048
    s_waitcnt lgkmcnt(4)
    v_mfma_f32_32x32x16_bf16 v[56:71], v[28:31], v[20:23], v[56:71]
    ds_read_b128 v[28:31], v10 offset:6144
    s_waitcnt lgkmcnt(4)
    v_mfma_f32_32x32x16_bf16 v[72:87], v[32:35], v[20:23], v[72:87]
    ds_read_b128 v[32:35], v10 offset:10240
    s_waitcnt lgkmcnt(4)
    v_mfma_f32_32x32x16_bf16 v[88:103], v[36:39], v[20:23], v[88:103]
    ds_read_b128 v[36:39], v10 offset:14336
    ds_read_b128 v[20:23], v13 offset:3072
    s_waitcnt lgkmcnt(4)
    v_mfma_f32_32x32x16_bf16 v[40:55], v[24:27], v[16:19], v[40:55]
    ds_read_b128 v[24:27], v10 offset:3072
    s_waitcnt lgkmcnt(4)
    v_mfma_f32_32x32x16_bf16 v[56:71], v[28:31], v[16:19], v[56:71]
    ds_read_b128 v[28:31], v10 offset:7168
    s_waitcnt lgkmcnt(4)
    v_mfma_f32_32x32x16_bf16 v[72:87], v[32:35], v[16:19], v[72:87]
    ds_read_b128 v[32:35], v10 offset:11264
    s_waitcnt lgkmcnt(4)
    v_mfma_f32_32x32x16_bf16 v[88:103], v[36:39], v[16:19], v[88:103]
    ds_read_b128 v[36:39], v10 offset:15360
    s_waitcnt vmcnt(4) lgkmcnt(0)
    s_barrier
    ds_read_b128 v[16:19], v13 offset:16384
    v_mfma_f32_32x32x16_bf16 v[40:55], v[24:27], v[20:23], v[40:55]
    ds_read_b128 v[24:27], v11 offset:0
    s_add_u32 s39, s38, 12288
    s_add_u32 m0, s40, 0
    s_nop 0
    buffer_load_dwordx4 v112, s[20:23], s39 offen offset:0 sc1 lds
    v_mfma_f32_32x32x16_bf16 v[56:71], v[28:31], v[20:23], v[56:71]
    ds_read_b128 v[28:31], v11 offset:4096
    buffer_load_dwordx4 v112, s[20:23], s39 offen offset:1024 sc1 lds
    v_mfma_f32_32x32x16_bf16 v[72:87], v[32:35], v[20:23], v[72:87]
    ds_read_b128 v[32:35], v11 offset:8192
    buffer_load_dwordx4 v112, s[20:23], s39 offen offset:2048 sc1 lds
    v_mfma_f32_32x32x16_bf16 v[88:103], v[36:39], v[20:23], v[88:103]
    ds_read_b128 v[36:39], v11 offset:12288
    buffer_load_dwordx4 v112, s[20:23], s39 offen offset:3072 sc1 lds
    ds_read_b128 v[20:23], v13 offset:17408
    s_waitcnt lgkmcnt(4)
    v_mfma_f32_32x32x16_bf16 v[40:55], v[24:27], v[16:19], v[40:55]
    ds_read_b128 v[24:27], v11 offset:1024
    s_add_u32 s37, s32, 12288
    s_add_u32 m0, s34, 0
    s_nop 0
    buffer_load_dwordx4 v124, s[20:23], s37 offen sc1 lds
    s_waitcnt lgkmcnt(4)
    v_mfma_f32_32x32x16_bf16 v[56:71], v[28:31], v[16:19], v[56:71]
    ds_read_b128 v[28:31], v11 offset:5120
    s_add_u32 m0, s34, 1024
    s_nop 0
    buffer_load_dwordx4 v125, s[20:23], s37 offen sc1 lds
    s_waitcnt lgkmcnt(4)
    v_mfma_f32_32x32x16_bf16 v[72:87], v[32:35], v[16:19], v[72:87]
    ds_read_b128 v[32:35], v11 offset:9216
    s_lshl_b32 s43, s29, 12
    s_add_u32 s43, s43, 10485760
    v_lshlrev_b32 v8, 3, v1
    buffer_load_dwordx2 v[128:129], v8, s[20:23], s43 offen sc1
    s_waitcnt lgkmcnt(4)
    v_mfma_f32_32x32x16_bf16 v[88:103], v[36:39], v[16:19], v[88:103]
    ds_read_b128 v[36:39], v11 offset:13312
    buffer_load_dwordx2 v[130:131], v8, s[20:23], s43 offen offset:512 sc1
    ds_read_b128 v[16:19], v13 offset:18432
    s_waitcnt lgkmcnt(4)
    v_mfma_f32_32x32x16_bf16 v[40:55], v[24:27], v[20:23], v[40:55]
    ds_read_b128 v[24:27], v11 offset:2048
    buffer_load_dwordx2 v[132:133], v8, s[20:23], s43 offen offset:1024 sc1
    s_waitcnt lgkmcnt(4)
    v_mfma_f32_32x32x16_bf16 v[56:71], v[28:31], v[20:23], v[56:71]
    ds_read_b128 v[28:31], v11 offset:6144
    buffer_load_dwordx2 v[134:135], v8, s[20:23], s43 offen offset:1536 sc1
    s_waitcnt lgkmcnt(4)
    v_mfma_f32_32x32x16_bf16 v[72:87], v[32:35], v[20:23], v[72:87]
    ds_read_b128 v[32:35], v11 offset:10240
    buffer_load_dwordx2 v[136:137], v8, s[20:23], s43 offen offset:2048 sc1
    s_waitcnt lgkmcnt(4)
    v_mfma_f32_32x32x16_bf16 v[88:103], v[36:39], v[20:23], v[88:103]
    ds_read_b128 v[36:39], v11 offset:14336
    buffer_load_dwordx2 v[138:139], v8, s[20:23], s43 offen offset:2560 sc1
    ds_read_b128 v[20:23], v13 offset:19456
    s_waitcnt lgkmcnt(4)
    v_mfma_f32_32x32x16_bf16 v[40:55], v[24:27], v[16:19], v[40:55]
    ds_read_b128 v[24:27], v11 offset:3072
    buffer_load_dwordx2 v[140:141], v8, s[20:23], s43 offen offset:3072 sc1
    s_waitcnt lgkmcnt(4)
    v_mfma_f32_32x32x16_bf16 v[56:71], v[28:31], v[16:19], v[56:71]
    ds_read_b128 v[28:31], v11 offset:7168
    s_waitcnt lgkmcnt(4)
    v_mfma_f32_32x32x16_bf16 v[72:87], v[32:35], v[16:19], v[72:87]
    ds_read_b128 v[32:35], v11 offset:11264
    buffer_load_dwordx2 v[142:143], v8, s[20:23], s43 offen offset:3584 sc1
    s_waitcnt lgkmcnt(4)
    v_mfma_f32_32x32x16_bf16 v[88:103], v[36:39], v[16:19], v[88:103]
    ds_read_b128 v[36:39], v11 offset:15360
    v_min_u32 v5, 223, v0
    v_cmp_lt_u32 vcc, 111, v5
    v_mov_b32 v6, 1680
    s_nop 0
    v_cndmask_b32 v6, 0, v6, vcc
    v_add_u32 v6, v6, v5
    v_lshlrev_b32 v6, 4, v6
    v_lshlrev_b32 v9, 2, v5
    v_add_u32 v9, 135168, v9
    s_mul_i32 s44, s28, 1792
    s_add_u32 s44, s44, 11534336
    buffer_load_dwordx4 v[144:147], v6, s[20:23], s44 offen sc1
    s_add_u32 s44, s44, 57344
    buffer_load_dwordx4 v[148:151], v6, s[20:23], s44 offen sc1
    s_add_u32 s44, s44, 57344
    buffer_load_dwordx4 v[152:155], v6, s[20:23], s44 offen sc1
    s_add_u32 s44, s44, 57344
    buffer_load_dwordx4 v[156:159], v6, s[20:23], s44 offen sc1
    s_waitcnt vmcnt(18) lgkmcnt(0)
    s_barrier
    ds_read_b128 v[16:19], v13 offset:32768
    v_mfma_f32_32x32x16_bf16 v[40:55], v[24:27], v[20:23], v[40:55]
    ds_read_b128 v[24:27], v12 offset:0
    s_add_u32 s39, s38, 16384
    s_add_u32 m0, s40, 16384
    s_nop 0
    buffer_load_dwordx4 v112, s[20:23], s39 offen offset:0 sc1 lds
    v_mfma_f32_32x32x16_bf16 v[56:71], v[28:31], v[20:23], v[56:71]
    ds_read_b128 v[28:31], v12 offset:4096
    v_mfma_f32_32x32x16_bf16 v[72:87], v[32:35], v[20:23], v[72:87]
    ds_read_b128 v[32:35], v12 offset:8192
    buffer_load_dwordx4 v112, s[20:23], s39 offen offset:1024 sc1 lds
    v_mfma_f32_32x32x16_bf16 v[88:103], v[36:39], v[20:23], v[88:103]
    ds_read_b128 v[36:39], v12 offset:12288
    ds_read_b128 v[20:23], v13 offset:33792
    s_waitcnt lgkmcnt(4)
    v_mfma_f32_32x32x16_bf16 v[40:55], v[24:27], v[16:19], v[40:55]
    ds_read_b128 v[24:27], v12 offset:1024
    buffer_load_dwordx4 v112, s[20:23], s39 offen offset:2048 sc1 lds
    s_waitcnt lgkmcnt(4)
    v_mfma_f32_32x32x16_bf16 v[56:71], v[28:31], v[16:19], v[56:71]
    ds_read_b128 v[28:31], v12 offset:5120
    s_waitcnt lgkmcnt(4)
    v_mfma_f32_32x32x16_bf16 v[72:87], v[32:35], v[16:19], v[72:87]
    ds_read_b128 v[32:35], v12 offset:9216
    buffer_load_dwordx4 v112, s[20:23], s39 offen offset:3072 sc1 lds
    s_waitcnt lgkmcnt(4)
    v_mfma_f32_32x32x16_bf16 v[88:103], v[36:39], v[16:19], v[88:103]
    ds_read_b128 v[36:39], v12 offset:13312
    ds_read_b128 v[16:19], v13 offset:34816
    s_waitcnt lgkmcnt(4)
    v_mfma_f32_32x32x16_bf16 v[40:55], v[24:27], v[20:23], v[40:55]
    ds_read_b128 v[24:27], v12 offset:2048
    s_add_u32 s37, s32, 16384
    s_add_u32 m0, s34, 28672
    s_nop 0
    buffer_load_dwordx4 v124, s[20:23], s37 offen sc1 lds
    s_waitcnt lgkmcnt(4)
    v_mfma_f32_32x32x16_bf16 v[56:71], v[28:31], v[20:23], v[56:71]
    ds_read_b128 v[28:31], v12 offset:6144
    s_waitcnt lgkmcnt(4)
    v_mfma_f32_32x32x16_bf16 v[72:87], v[32:35], v[20:23], v[72:87]
    ds_read_b128 v[32:35], v12 offset:10240
    s_add_u32 m0, s34, 29696
    s_nop 0
    buffer_load_dwordx4 v125, s[20:23], s37 offen sc1 lds
    s_waitcnt lgkmcnt(4)
    v_mfma_f32_32x32x16_bf16 v[88:103], v[36:39], v[20:23], v[88:103]
    ds_read_b128 v[36:39], v12 offset:14336
    ds_read_b128 v[20:23], v13 offset:35840
    s_waitcnt lgkmcnt(4)
    v_mfma_f32_32x32x16_bf16 v[40:55], v[24:27], v[16:19], v[40:55]
    ds_read_b128 v[24:27], v12 offset:3072
    s_waitcnt lgkmcnt(4)
    v_mfma_f32_32x32x16_bf16 v[56:71], v[28:31], v[16:19], v[56:71]
    ds_read_b128 v[28:31], v12 offset:7168
    s_waitcnt lgkmcnt(4)
    v_mfma_f32_32x32x16_bf16 v[72:87], v[32:35], v[16:19], v[72:87]
    ds_read_b128 v[32:35], v12 offset:11264
    s_waitcnt lgkmcnt(4)
    v_mfma_f32_32x32x16_bf16 v[88:103], v[36:39], v[16:19], v[88:103]
    ds_read_b128 v[36:39], v12 offset:15360
    s_waitcnt vmcnt(18) lgkmcnt(0)
    s_barrier
    ds_read_b128 v[16:19], v13 offset:0
    v_mfma_f32_32x32x16_bf16 v[40:55], v[24:27], v[20:23], v[40:55]
    ds_read_b128 v[24:27], v10 offset:0
    s_add_u32 s39, s38, 20480
    s_add_u32 m0, s40, 32768
    s_nop 0
    buffer_load_dwordx4 v112, s[20:23], s39 offen offset:0 sc1 lds
    v_mfma_f32_32x32x16_bf16 v[56:71], v[28:31], v[20:23], v[56:71]
    ds_read_b128 v[28:31], v10 offset:4096
    v_mfma_f32_32x32x16_bf16 v[72:87], v[32:35], v[20:23], v[72:87]
    ds_read_b128 v[32:35], v10 offset:8192
    buffer_load_dwordx4 v112, s[20:23], s39 offen offset:1024 sc1 lds
    v_mfma_f32_32x32x16_bf16 v[88:103], v[36:39], v[20:23], v[88:103]
    ds_read_b128 v[36:39], v10 offset:12288
    ds_read_b128 v[20:23], v13 offset:1024
    s_waitcnt lgkmcnt(4)
    v_mfma_f32_32x32x16_bf16 v[40:55], v[24:27], v[16:19], v[40:55]
    ds_read_b128 v[24:27], v10 offset:1024
    buffer_load_dwordx4 v112, s[20:23], s39 offen offset:2048 sc1 lds
    s_waitcnt lgkmcnt(4)
    v_mfma_f32_32x32x16_bf16 v[56:71], v[28:31], v[16:19], v[56:71]
    ds_read_b128 v[28:31], v10 offset:5120
    s_waitcnt lgkmcnt(4)
    v_mfma_f32_32x32x16_bf16 v[72:87], v[32:35], v[16:19], v[72:87]
    ds_read_b128 v[32:35], v10 offset:9216
    buffer_load_dwordx4 v112, s[20:23], s39 offen offset:3072 sc1 lds
    s_waitcnt lgkmcnt(4)
    v_mfma_f32_32x32x16_bf16 v[88:103], v[36:39], v[16:19], v[88:103]
    ds_read_b128 v[36:39], v10 offset:13312
    ds_read_b128 v[16:19], v13 offset:2048
    s_waitcnt lgkmcnt(4)
    v_mfma_f32_32x32x16_bf16 v[40:55], v[24:27], v[20:23], v[40:55]
    ds_read_b128 v[24:27], v10 offset:2048
    s_add_u32 s37, s32, 20480
    s_add_u32 m0, s34, 57344
    s_nop 0
    buffer_load_dwordx4 v124, s[20:23], s37 offen sc1 lds
    s_waitcnt lgkmcnt(4)
    v_mfma_f32_32x32x16_bf16 v[56:71], v[28:31], v[20:23], v[56:71]
    ds_read_b128 v[28:31], v10 offset:6144
    s_waitcnt lgkmcnt(4)
    v_mfma_f32_32x32x16_bf16 v[72:87], v[32:35], v[20:23], v[72:87]
    ds_read_b128 v[32:35], v10 offset:10240
    s_add_u32 m0, s34, 58368
    s_nop 0
    buffer_load_dwordx4 v125, s[20:23], s37 offen sc1 lds
    s_waitcnt lgkmcnt(4)
    v_mfma_f32_32x32x16_bf16 v[88:103], v[36:39], v[20:23], v[88:103]
    ds_read_b128 v[36:39], v10 offset:14336
    s_waitcnt vmcnt(12)
    v_add_f32 v144, v144, v152
    v_add_f32 v145, v145, v153
    v_add_f32 v146, v146, v154
    v_add_f32 v147, v147, v155
    v_add_f32 v148, v148, v156
    v_add_f32 v149, v149, v157
    v_add_f32 v150, v150, v158
    v_add_f32 v151, v151, v159
    v_add_f32 v144, v144, v148
    v_add_f32 v145, v145, v149
    v_add_f32 v146, v146, v150
    v_add_f32 v147, v147, v151
    v_add_f32 v144, v144, v146
    v_add_f32 v145, v145, v147
    v_add_f32 v144, v144, v145
    v_add_f32 v128, v128, v130
    v_add_f32 v129, v129, v131
    v_add_f32 v128, v128, v132
    v_add_f32 v129, v129, v133
    v_add_f32 v128, v128, v134
    v_add_f32 v129, v129, v135
    v_add_f32 v128, v128, v136
    v_add_f32 v129, v129, v137
    v_add_f32 v128, v128, v138
    v_add_f32 v129, v129, v139
    v_add_f32 v128, v128, v140
    v_add_f32 v129, v129, v141
    v_add_f32 v128, v128, v142
    v_add_f32 v129, v129, v143
    v_mov_b32 v130, v128
    v_mov_b32 v131, v129
    s_nop 0
    v_permlane32_swap_b32 v128, v130
    v_permlane32_swap_b32 v129, v131
    v_add_f32 v128, v128, v130
    v_add_f32 v129, v129, v131
    v_mul_f32 v117, 0x3b000000, v128
    v_mul_f32 v122, 0x3b000000, v129
    v_fma_f32 v122, -v117, v117, v122
    v_max_f32 v122, 0, v122
    v_add_f32 v122, 0x3727c5ac, v122
    v_rsq_f32 v120, v122
    s_nop 0
    v_mul_f32 v120, 0xbfb8aa3b, v120
    v_mov_b32 v121, v120
    v_mov_b32 v123, v122
    v_sub_f32 v118, 0, v117
    v_sub_f32 v119, 0, v117
    ds_read_b128 v[20:23], v13 offset:3072
    s_waitcnt lgkmcnt(4)
    v_mfma_f32_32x32x16_bf16 v[40:55], v[24:27], v[16:19], v[40:55]
    ds_read_b128 v[24:27], v10 offset:3072
    s_waitcnt lgkmcnt(4)
    v_mfma_f32_32x32x16_bf16 v[56:71], v[28:31], v[16:19], v[56:71]
    ds_read_b128 v[28:31], v10 offset:7168
    s_waitcnt lgkmcnt(4)
    v_mfma_f32_32x32x16_bf16 v[72:87], v[32:35], v[16:19], v[72:87]
    ds_read_b128 v[32:35], v10 offset:11264
    s_waitcnt lgkmcnt(4)
    v_mfma_f32_32x32x16_bf16 v[88:103], v[36:39], v[16:19], v[88:103]
    ds_read_b128 v[36:39], v10 offset:15360
    s_waitcnt vmcnt(6) lgkmcnt(0)
    s_barrier
    ds_read_b128 v[16:19], v13 offset:16384
    v_mfma_f32_32x32x16_bf16 v[40:55], v[24:27], v[20:23], v[40:55]
    ds_read_b128 v[24:27], v11 offset:0
    s_add_u32 s39, s38, 24576
    s_add_u32 m0, s40, 0
    s_nop 0
    buffer_load_dwordx4 v112, s[20:23], s39 offen offset:0 sc1 lds
    v_mfma_f32_32x32x16_bf16 v[56:71], v[28:31], v[20:23], v[56:71]
    ds_read_b128 v[28:31], v11 offset:4096
    v_mfma_f32_32x32x16_bf16 v[72:87], v[32:35], v[20:23], v[72:87]
    ds_read_b128 v[32:35], v11 offset:8192
    buffer_load_dwordx4 v112, s[20:23], s39 offen offset:1024 sc1 lds
    v_mfma_f32_32x32x16_bf16 v[88:103], v[36:39], v[20:23], v[88:103]
    ds_read_b128 v[36:39], v11 offset:12288
    ds_read_b128 v[20:23], v13 offset:17408
    s_waitcnt lgkmcnt(4)
    v_mfma_f32_32x32x16_bf16 v[40:55], v[24:27], v[16:19], v[40:55]
    ds_read_b128 v[24:27], v11 offset:1024
    buffer_load_dwordx4 v112, s[20:23], s39 offen offset:2048 sc1 lds
    s_waitcnt lgkmcnt(4)
    v_mfma_f32_32x32x16_bf16 v[56:71], v[28:31], v[16:19], v[56:71]
    ds_read_b128 v[28:31], v11 offset:5120
    s_waitcnt lgkmcnt(4)
    v_mfma_f32_32x32x16_bf16 v[72:87], v[32:35], v[16:19], v[72:87]
    ds_read_b128 v[32:35], v11 offset:9216
    buffer_load_dwordx4 v112, s[20:23], s39 offen offset:3072 sc1 lds
    s_waitcnt lgkmcnt(4)
    v_mfma_f32_32x32x16_bf16 v[88:103], v[36:39], v[16:19], v[88:103]
    ds_read_b128 v[36:39], v11 offset:13312
    ds_read_b128 v[16:19], v13 offset:18432
    s_waitcnt lgkmcnt(4)
    v_mfma_f32_32x32x16_bf16 v[40:55], v[24:27], v[20:23], v[40:55]
    ds_read_b128 v[24:27], v11 offset:2048
    s_add_u32 s37, s32, 24576
    s_add_u32 m0, s34, 0
    s_nop 0
    buffer_load_dwordx4 v124, s[20:23], s37 offen sc1 lds
    s_waitcnt lgkmcnt(4)
    v_mfma_f32_32x32x16_bf16 v[56:71], v[28:31], v[20:23], v[56:71]
    ds_read_b128 v[28:31], v11 offset:6144
    s_waitcnt lgkmcnt(4)
    v_mfma_f32_32x32x16_bf16 v[72:87], v[32:35], v[20:23], v[72:87]
    ds_read_b128 v[32:35], v11 offset:10240
    s_add_u32 m0, s34, 1024
    s_nop 0
    buffer_load_dwordx4 v125, s[20:23], s37 offen sc1 lds
    s_waitcnt lgkmcnt(4)
    v_mfma_f32_32x32x16_bf16 v[88:103], v[36:39], v[20:23], v[88:103]
    ds_read_b128 v[36:39], v11 offset:14336
    ds_read_b128 v[20:23], v13 offset:19456
    s_waitcnt lgkmcnt(4)
    v_mfma_f32_32x32x16_bf16 v[40:55], v[24:27], v[16:19], v[40:55]
    ds_read_b128 v[24:27], v11 offset:3072
    s_waitcnt lgkmcnt(4)
    v_mfma_f32_32x32x16_bf16 v[56:71], v[28:31], v[16:19], v[56:71]
    ds_read_b128 v[28:31], v11 offset:7168
    s_waitcnt lgkmcnt(4)
    v_mfma_f32_32x32x16_bf16 v[72:87], v[32:35], v[16:19], v[72:87]
    ds_read_b128 v[32:35], v11 offset:11264
    s_waitcnt lgkmcnt(4)
    v_mfma_f32_32x32x16_bf16 v[88:103], v[36:39], v[16:19], v[88:103]
    ds_read_b128 v[36:39], v11 offset:15360
    s_waitcnt vmcnt(6) lgkmcnt(0)
    s_barrier
    ds_read_b128 v[16:19], v13 offset:32768
    v_mfma_f32_32x32x16_bf16 v[40:55], v[24:27], v[20:23], v[40:55]
    ds_read_b128 v[24:27], v12 offset:0
    s_add_u32 s39, s38, 28672
    s_add_u32 m0, s40, 16384
    s_nop 0
    buffer_load_dwordx4 v112, s[20:23], s39 offen offset:0 sc1 lds
    v_mfma_f32_32x32x16_bf16 v[56:71], v[28:31], v[20:23], v[56:71]
    ds_read_b128 v[28:31], v12 offset:4096
    v_mfma_f32_32x32x16_bf16 v[72:87], v[32:35], v[20:23], v[72:87]
    ds_read_b128 v[32:35], v12 offset:8192
    buffer_load_dwordx4 v112, s[20:23], s39 offen offset:1024 sc1 lds
    v_mfma_f32_32x32x16_bf16 v[88:103], v[36:39], v[20:23], v[88:103]
    ds_read_b128 v[36:39], v12 offset:12288
    ds_read_b128 v[20:23], v13 offset:33792
    s_waitcnt lgkmcnt(4)
    v_mfma_f32_32x32x16_bf16 v[40:55], v[24:27], v[16:19], v[40:55]
    ds_read_b128 v[24:27], v12 offset:1024
    buffer_load_dwordx4 v112, s[20:23], s39 offen offset:2048 sc1 lds
    s_waitcnt lgkmcnt(4)
    v_mfma_f32_32x32x16_bf16 v[56:71], v[28:31], v[16:19], v[56:71]
    ds_read_b128 v[28:31], v12 offset:5120
    s_waitcnt lgkmcnt(4)
    v_mfma_f32_32x32x16_bf16 v[72:87], v[32:35], v[16:19], v[72:87]
    ds_read_b128 v[32:35], v12 offset:9216
    buffer_load_dwordx4 v112, s[20:23], s39 offen offset:3072 sc1 lds
    s_waitcnt lgkmcnt(4)
    v_mfma_f32_32x32x16_bf16 v[88:103], v[36:39], v[16:19], v[88:103]
    ds_read_b128 v[36:39], v12 offset:13312
    ds_read_b128 v[16:19], v13 offset:34816
    s_waitcnt lgkmcnt(4)
    v_mfma_f32_32x32x16_bf16 v[40:55], v[24:27], v[20:23], v[40:55]
    ds_read_b128 v[24:27], v12 offset:2048
    s_add_u32 s37, s32, 28672
    s_add_u32 m0, s34, 28672
    s_nop 0
    buffer_load_dwordx4 v124, s[20:23], s37 offen sc1 lds
    s_waitcnt lgkmcnt(4)
    v_mfma_f32_32x32x16_bf16 v[56:71], v[28:31], v[20:23], v[56:71]
    ds_read_b128 v[28:31], v12 offset:6144
    s_waitcnt lgkmcnt(4)
    v_mfma_f32_32x32x16_bf16 v[72:87], v[32:35], v[20:23], v[72:87]
    ds_read_b128 v[32:35], v12 offset:10240
    s_add_u32 m0, s34, 29696
    s_nop 0
    buffer_load_dwordx4 v125, s[20:23], s37 offen sc1 lds
    s_waitcnt lgkmcnt(4)
    v_mfma_f32_32x32x16_bf16 v[88:103], v[36:39], v[20:23], v[88:103]
    ds_read_b128 v[36:39], v12 offset:14336
    ds_read_b128 v[20:23], v13 offset:35840
    s_waitcnt lgkmcnt(4)
    v_mfma_f32_32x32x16_bf16 v[40:55], v[24:27], v[16:19], v[40:55]
    ds_read_b128 v[24:27], v12 offset:3072
    s_waitcnt lgkmcnt(4)
    v_mfma_f32_32x32x16_bf16 v[56:71], v[28:31], v[16:19], v[56:71]
    ds_read_b128 v[28:31], v12 offset:7168
    s_waitcnt lgkmcnt(4)
    v_mfma_f32_32x32x16_bf16 v[72:87], v[32:35], v[16:19], v[72:87]
    ds_read_b128 v[32:35], v12 offset:11264
    s_waitcnt lgkmcnt(4)
    v_mfma_f32_32x32x16_bf16 v[88:103], v[36:39], v[16:19], v[88:103]
    ds_read_b128 v[36:39], v12 offset:15360
    s_waitcnt vmcnt(6) lgkmcnt(0)
    s_barrier
    ds_read_b128 v[16:19], v13 offset:0
    v_mfma_f32_32x32x16_bf16 v[40:55], v[24:27], v[20:23], v[40:55]
    ds_read_b128 v[24:27], v10 offset:0
    v_mfma_f32_32x32x16_bf16 v[56:71], v[28:31], v[20:23], v[56:71]
    ds_read_b128 v[28:31], v10 offset:4096
    v_mfma_f32_32x32x16_bf16 v[72:87], v[32:35], v[20:23], v[72:87]
    ds_read_b128 v[32:35], v10 offset:8192
    v_mfma_f32_32x32x16_bf16 v[88:103], v[36:39], v[20:23], v[88:103]
    ds_read_b128 v[36:39], v10 offset:12288
    ds_read_b128 v[20:23], v13 offset:1024
    s_waitcnt lgkmcnt(4)
    v_mfma_f32_32x32x16_bf16 v[40:55], v[24:27], v[16:19], v[40:55]
    ds_read_b128 v[24:27], v10 offset:1024
    s_waitcnt lgkmcnt(4)
    v_mfma_f32_32x32x16_bf16 v[56:71], v[28:31], v[16:19], v[56:71]
    ds_read_b128 v[28:31], v10 offset:5120
    s_waitcnt lgkmcnt(4)
    v_mfma_f32_32x32x16_bf16 v[72:87], v[32:35], v[16:19], v[72:87]
    ds_read_b128 v[32:35], v10 offset:9216
    s_waitcnt lgkmcnt(4)
    v_mfma_f32_32x32x16_bf16 v[88:103], v[36:39], v[16:19], v[88:103]
    ds_read_b128 v[36:39], v10 offset:13312
    ds_read_b128 v[16:19], v13 offset:2048
    s_waitcnt lgkmcnt(4)
    v_mfma_f32_32x32x16_bf16 v[40:55], v[24:27], v[20:23], v[40:55]
    ds_read_b128 v[24:27], v10 offset:2048
    s_waitcnt lgkmcnt(4)
    v_mfma_f32_32x32x16_bf16 v[56:71], v[28:31], v[20:23], v[56:71]
    ds_read_b128 v[28:31], v10 offset:6144
    s_waitcnt lgkmcnt(4)
    v_mfma_f32_32x32x16_bf16 v[72:87], v[32:35], v[20:23], v[72:87]
    ds_read_b128 v[32:35], v10 offset:10240
    s_waitcnt lgkmcnt(4)
    v_mfma_f32_32x32x16_bf16 v[88:103], v[36:39], v[20:23], v[88:103]
    ds_read_b128 v[36:39], v10 offset:14336
    ds_read_b128 v[20:23], v13 offset:3072
    s_waitcnt lgkmcnt(4)
    v_mfma_f32_32x32x16_bf16 v[40:55], v[24:27], v[16:19], v[40:55]
    ds_read_b128 v[24:27], v10 offset:3072
    s_waitcnt lgkmcnt(4)
    v_mfma_f32_32x32x16_bf16 v[56:71], v[28:31], v[16:19], v[56:71]
    ds_read_b128 v[28:31], v10 offset:7168
    s_waitcnt lgkmcnt(4)
    v_mfma_f32_32x32x16_bf16 v[72:87], v[32:35], v[16:19], v[72:87]
    ds_read_b128 v[32:35], v10 offset:11264
    s_waitcnt lgkmcnt(4)
    v_mfma_f32_32x32x16_bf16 v[88:103], v[36:39], v[16:19], v[88:103]
    ds_read_b128 v[36:39], v10 offset:15360
    s_waitcnt vmcnt(0) lgkmcnt(0)
    s_barrier
    ds_read_b128 v[16:19], v13 offset:16384
    v_mfma_f32_32x32x16_bf16 v[40:55], v[24:27], v[20:23], v[40:55]
    ds_read_b128 v[24:27], v11 offset:0
    v_mfma_f32_32x32x16_bf16 v[56:71], v[28:31], v[20:23], v[56:71]
    ds_read_b128 v[28:31], v11 offset:4096
    v_mfma_f32_32x32x16_bf16 v[72:87], v[32:35], v[20:23], v[72:87]
    ds_read_b128 v[32:35], v11 offset:8192
    v_mfma_f32_32x32x16_bf16 v[88:103], v[36:39], v[20:23], v[88:103]
    ds_read_b128 v[36:39], v11 offset:12288
    ds_read_b128 v[20:23], v13 offset:17408
    s_waitcnt lgkmcnt(4)
    v_mfma_f32_32x32x16_bf16 v[40:55], v[24:27], v[16:19], v[40:55]
    ds_read_b128 v[24:27], v11 offset:1024
    s_waitcnt lgkmcnt(4)
    v_mfma_f32_32x32x16_bf16 v[56:71], v[28:31], v[16:19], v[56:71]
    ds_read_b128 v[28:31], v11 offset:5120
    s_waitcnt lgkmcnt(4)
    v_mfma_f32_32x32x16_bf16 v[72:87], v[32:35], v[16:19], v[72:87]
    ds_read_b128 v[32:35], v11 offset:9216
    s_waitcnt lgkmcnt(4)
    v_mfma_f32_32x32x16_bf16 v[88:103], v[36:39], v[16:19], v[88:103]
    ds_read_b128 v[36:39], v11 offset:13312
    ds_read_b128 v[16:19], v13 offset:18432
    s_waitcnt lgkmcnt(4)
    v_mfma_f32_32x32x16_bf16 v[40:55], v[24:27], v[20:23], v[40:55]
    ds_read_b128 v[24:27], v11 offset:2048
    s_waitcnt lgkmcnt(4)
    v_mfma_f32_32x32x16_bf16 v[56:71], v[28:31], v[20:23], v[56:71]
    ds_read_b128 v[28:31], v11 offset:6144
    s_waitcnt lgkmcnt(4)
    v_mfma_f32_32x32x16_bf16 v[72:87], v[32:35], v[20:23], v[72:87]
    ds_read_b128 v[32:35], v11 offset:10240
    s_waitcnt lgkmcnt(4)
    v_mfma_f32_32x32x16_bf16 v[88:103], v[36:39], v[20:23], v[88:103]
    ds_read_b128 v[36:39], v11 offset:14336
    ds_read_b128 v[20:23], v13 offset:19456
    s_waitcnt lgkmcnt(4)
    v_mfma_f32_32x32x16_bf16 v[40:55], v[24:27], v[16:19], v[40:55]
    ds_read_b128 v[24:27], v11 offset:3072
    s_waitcnt lgkmcnt(4)
    v_mfma_f32_32x32x16_bf16 v[56:71], v[28:31], v[16:19], v[56:71]
    ds_read_b128 v[28:31], v11 offset:7168
    s_waitcnt lgkmcnt(4)
    v_mfma_f32_32x32x16_bf16 v[72:87], v[32:35], v[16:19], v[72:87]
    ds_read_b128 v[32:35], v11 offset:11264
    s_waitcnt lgkmcnt(4)
    v_mfma_f32_32x32x16_bf16 v[88:103], v[36:39], v[16:19], v[88:103]
    ds_read_b128 v[36:39], v11 offset:15360
    s_waitcnt lgkmcnt(3)
    v_mfma_f32_32x32x16_bf16 v[40:55], v[24:27], v[20:23], v[40:55]
    s_waitcnt lgkmcnt(2)
    v_mfma_f32_32x32x16_bf16 v[56:71], v[28:31], v[20:23], v[56:71]
    s_waitcnt lgkmcnt(1)
    v_mfma_f32_32x32x16_bf16 v[72:87], v[32:35], v[20:23], v[72:87]
    s_waitcnt lgkmcnt(0)
    v_mfma_f32_32x32x16_bf16 v[88:103], v[36:39], v[20:23], v[88:103]
    ds_write_b32 v9, v144
    s_waitcnt lgkmcnt(0)
    s_barrier
    s_mul_i32 s36, s29, 114688
    s_mul_i32 s37, s28, 7168
    s_add_u32 s36, s36, s37
    s_add_u32 s36, s36, 12582912
    ds_read_b128 v[160:163], v14 offset:0
    ds_read_b128 v[164:167], v14 offset:32
    ds_read_b128 v[168:171], v14 offset:448
    ds_read_b128 v[172:175], v14 offset:480
    s_waitcnt lgkmcnt(0)
    ds_read_b128 v[176:179], v14 offset:64
    ds_read_b128 v[180:183], v14 offset:96
    ds_read_b128 v[184:187], v14 offset:512
    ds_read_b128 v[188:191], v14 offset:544
    v_pk_fma_f32 v[40:41], v[118:119], v[160:161], v[40:41]
    v_pk_fma_f32 v[42:43], v[118:119], v[162:163], v[42:43]
    v_pk_fma_f32 v[44:45], v[118:119], v[164:165], v[44:45]
    v_pk_fma_f32 v[46:47], v[118:119], v[166:167], v[46:47]
    v_pk_fma_f32 v[48:49], v[118:119], v[168:169], v[48:49]
    v_pk_fma_f32 v[50:51], v[118:119], v[170:171], v[50:51]
    v_pk_fma_f32 v[52:53], v[118:119], v[172:173], v[52:53]
    v_pk_fma_f32 v[54:55], v[118:119], v[174:175], v[54:55]
    v_pk_mul_f32 v[144:145], v[40:41], v[120:121]
    v_pk_mul_f32 v[146:147], v[42:43], v[120:121]
    v_pk_mul_f32 v[148:149], v[44:45], v[120:121]
    v_pk_mul_f32 v[150:151], v[46:47], v[120:121]
    v_exp_f32 v144, v144
    v_exp_f32 v145, v145
    v_exp_f32 v146, v146
    v_exp_f32 v147, v147
    v_exp_f32 v148, v148
    v_exp_f32 v149, v149
    v_exp_f32 v150, v150
    v_exp_f32 v151, v151
    v_pk_mul_f32 v[40:41], v[40:41], v[48:49]
    v_pk_mul_f32 v[42:43], v[42:43], v[50:51]
    v_pk_mul_f32 v[44:45], v[44:45], v[52:53]
    v_pk_mul_f32 v[46:47], v[46:47], v[54:55]
    v_pk_fma_f32 v[144:145], v[144:145], v[122:123], v[122:123]
    v_pk_fma_f32 v[146:147], v[146:147], v[122:123], v[122:123]
    v_pk_fma_f32 v[148:149], v[148:149], v[122:123], v[122:123]
    v_pk_fma_f32 v[150:151], v[150:151], v[122:123], v[122:123]
    v_rcp_f32 v144, v144
    v_rcp_f32 v145, v145
    v_rcp_f32 v146, v146
    v_rcp_f32 v147, v147
    v_rcp_f32 v148, v148
    v_rcp_f32 v149, v149
    v_rcp_f32 v150, v150
    v_rcp_f32 v151, v151
    v_pk_mul_f32 v[40:41], v[40:41], v[144:145]
    v_pk_mul_f32 v[42:43], v[42:43], v[146:147]
    v_pk_mul_f32 v[44:45], v[44:45], v[148:149]
    v_pk_mul_f32 v[46:47], v[46:47], v[150:151]
    v_cvt_pk_bf16_f32 v40, v40, v41
    v_cvt_pk_bf16_f32 v41, v42, v43
    v_cvt_pk_bf16_f32 v42, v44, v45
    v_cvt_pk_bf16_f32 v43, v46, v47
    buffer_store_dwordx4 v[40:43], v112, s[20:23], s36 offen offset:0 sc1
    s_waitcnt lgkmcnt(0)
    ds_read_b128 v[160:163], v14 offset:128
    ds_read_b128 v[164:167], v14 offset:160
    ds_read_b128 v[168:171], v14 offset:576
    ds_read_b128 v[172:175], v14 offset:608
    v_pk_fma_f32 v[56:57], v[118:119], v[176:177], v[56:57]
    v_pk_fma_f32 v[58:59], v[118:119], v[178:179], v[58:59]
    v_pk_fma_f32 v[60:61], v[118:119], v[180:181], v[60:61]
    v_pk_fma_f32 v[62:63], v[118:119], v[182:183], v[62:63]
    v_pk_fma_f32 v[64:65], v[118:119], v[184:185], v[64:65]
    v_pk_fma_f32 v[66:67], v[118:119], v[186:187], v[66:67]
    v_pk_fma_f32 v[68:69], v[118:119], v[188:189], v[68:69]
    v_pk_fma_f32 v[70:71], v[118:119], v[190:191], v[70:71]
    v_pk_mul_f32 v[144:145], v[56:57], v[120:121]
    v_pk_mul_f32 v[146:147], v[58:59], v[120:121]
    v_pk_mul_f32 v[148:149], v[60:61], v[120:121]
    v_pk_mul_f32 v[150:151], v[62:63], v[120:121]
    v_exp_f32 v144, v144
    v_exp_f32 v145, v145
    v_exp_f32 v146, v146
    v_exp_f32 v147, v147
    v_exp_f32 v148, v148
    v_exp_f32 v149, v149
    v_exp_f32 v150, v150
    v_exp_f32 v151, v151
    v_pk_mul_f32 v[56:57], v[56:57], v[64:65]
    v_pk_mul_f32 v[58:59], v[58:59], v[66:67]
    v_pk_mul_f32 v[60:61], v[60:61], v[68:69]
    v_pk_mul_f32 v[62:63], v[62:63], v[70:71]
    v_pk_fma_f32 v[144:145], v[144:145], v[122:123], v[122:123]
    v_pk_fma_f32 v[146:147], v[146:147], v[122:123], v[122:123]
    v_pk_fma_f32 v[148:149], v[148:149], v[122:123], v[122:123]
    v_pk_fma_f32 v[150:151], v[150:151], v[122:123], v[122:123]
    v_rcp_f32 v144, v144
    v_rcp_f32 v145, v145
    v_rcp_f32 v146, v146
    v_rcp_f32 v147, v147
    v_rcp_f32 v148, v148
    v_rcp_f32 v149, v149
    v_rcp_f32 v150, v150
    v_rcp_f32 v151, v151
    v_pk_mul_f32 v[56:57], v[56:57], v[144:145]
    v_pk_mul_f32 v[58:59], v[58:59], v[146:147]
    v_pk_mul_f32 v[60:61], v[60:61], v[148:149]
    v_pk_mul_f32 v[62:63], v[62:63], v[150:151]
    v_cvt_pk_bf16_f32 v56, v56, v57
    v_cvt_pk_bf16_f32 v57, v58, v59
    v_cvt_pk_bf16_f32 v58, v60, v61
    v_cvt_pk_bf16_f32 v59, v62, v63
    buffer_store_dwordx4 v[56:59], v112, s[20:23], s36 offen offset:1024 sc1
    s_waitcnt lgkmcnt(0)
    ds_read_b128 v[176:179], v14 offset:192
    ds_read_b128 v[180:183], v14 offset:224
    ds_read_b128 v[184:187], v14 offset:640
    ds_read_b128 v[188:191], v14 offset:672
    v_pk_fma_f32 v[72:73], v[118:119], v[160:161], v[72:73]
    v_pk_fma_f32 v[74:75], v[118:119], v[162:163], v[74:75]
    v_pk_fma_f32 v[76:77], v[118:119], v[164:165], v[76:77]
    v_pk_fma_f32 v[78:79], v[118:119], v[166:167], v[78:79]
    v_pk_fma_f32 v[80:81], v[118:119], v[168:169], v[80:81]
    v_pk_fma_f32 v[82:83], v[118:119], v[170:171], v[82:83]
    v_pk_fma_f32 v[84:85], v[118:119], v[172:173], v[84:85]
    v_pk_fma_f32 v[86:87], v[118:119], v[174:175], v[86:87]
    v_pk_mul_f32 v[144:145], v[72:73], v[120:121]
    v_pk_mul_f32 v[146:147], v[74:75], v[120:121]
    v_pk_mul_f32 v[148:149], v[76:77], v[120:121]
    v_pk_mul_f32 v[150:151], v[78:79], v[120:121]
    v_exp_f32 v144, v144
    v_exp_f32 v145, v145
    v_exp_f32 v146, v146
    v_exp_f32 v147, v147
    v_exp_f32 v148, v148
    v_exp_f32 v149, v149
    v_exp_f32 v150, v150
    v_exp_f32 v151, v151
    v_pk_mul_f32 v[72:73], v[72:73], v[80:81]
    v_pk_mul_f32 v[74:75], v[74:75], v[82:83]
    v_pk_mul_f32 v[76:77], v[76:77], v[84:85]
    v_pk_mul_f32 v[78:79], v[78:79], v[86:87]
    v_pk_fma_f32 v[144:145], v[144:145], v[122:123], v[122:123]
    v_pk_fma_f32 v[146:147], v[146:147], v[122:123], v[122:123]
    v_pk_fma_f32 v[148:149], v[148:149], v[122:123], v[122:123]
    v_pk_fma_f32 v[150:151], v[150:151], v[122:123], v[122:123]
    v_rcp_f32 v144, v144
    v_rcp_f32 v145, v145
    v_rcp_f32 v146, v146
    v_rcp_f32 v147, v147
    v_rcp_f32 v148, v148
    v_rcp_f32 v149, v149
    v_rcp_f32 v150, v150
    v_rcp_f32 v151, v151
    v_pk_mul_f32 v[72:73], v[72:73], v[144:145]
    v_pk_mul_f32 v[74:75], v[74:75], v[146:147]
    v_pk_mul_f32 v[76:77], v[76:77], v[148:149]
    v_pk_mul_f32 v[78:79], v[78:79], v[150:151]
    v_cvt_pk_bf16_f32 v72, v72, v73
    v_cvt_pk_bf16_f32 v73, v74, v75
    v_cvt_pk_bf16_f32 v74, v76, v77
    v_cvt_pk_bf16_f32 v75, v78, v79
    buffer_store_dwordx4 v[72:75], v112, s[20:23], s36 offen offset:2048 sc1
    s_waitcnt lgkmcnt(0)
    v_pk_fma_f32 v[88:89], v[118:119], v[176:177], v[88:89]
    v_pk_fma_f32 v[90:91], v[118:119], v[178:179], v[90:91]
    v_pk_fma_f32 v[92:93], v[118:119], v[180:181], v[92:93]
    v_pk_fma_f32 v[94:95], v[118:119], v[182:183], v[94:95]
    v_pk_fma_f32 v[96:97], v[118:119], v[184:185], v[96:97]
    v_pk_fma_f32 v[98:99], v[118:119], v[186:187], v[98:99]
    v_pk_fma_f32 v[100:101], v[118:119], v[188:189], v[100:101]
    v_pk_fma_f32 v[102:103], v[118:119], v[190:191], v[102:103]
    v_pk_mul_f32 v[144:145], v[88:89], v[120:121]
    v_pk_mul_f32 v[146:147], v[90:91], v[120:121]
    v_pk_mul_f32 v[148:149], v[92:93], v[120:121]
    v_pk_mul_f32 v[150:151], v[94:95], v[120:121]
    v_exp_f32 v144, v144
    v_exp_f32 v145, v145
    v_exp_f32 v146, v146
    v_exp_f32 v147, v147
    v_exp_f32 v148, v148
    v_exp_f32 v149, v149
    v_exp_f32 v150, v150
    v_exp_f32 v151, v151
    v_pk_mul_f32 v[88:89], v[88:89], v[96:97]
    v_pk_mul_f32 v[90:91], v[90:91], v[98:99]
    v_pk_mul_f32 v[92:93], v[92:93], v[100:101]
    v_pk_mul_f32 v[94:95], v[94:95], v[102:103]
    v_pk_fma_f32 v[144:145], v[144:145], v[122:123], v[122:123]
    v_pk_fma_f32 v[146:147], v[146:147], v[122:123], v[122:123]
    v_pk_fma_f32 v[148:149], v[148:149], v[122:123], v[122:123]
    v_pk_fma_f32 v[150:151], v[150:151], v[122:123], v[122:123]
    v_rcp_f32 v144, v144
    v_rcp_f32 v145, v145
    v_rcp_f32 v146, v146
    v_rcp_f32 v147, v147
    v_rcp_f32 v148, v148
    v_rcp_f32 v149, v149
    v_rcp_f32 v150, v150
    v_rcp_f32 v151, v151
    v_pk_mul_f32 v[88:89], v[88:89], v[144:145]
    v_pk_mul_f32 v[90:91], v[90:91], v[146:147]
    v_pk_mul_f32 v[92:93], v[92:93], v[148:149]
    v_pk_mul_f32 v[94:95], v[94:95], v[150:151]
    v_cvt_pk_bf16_f32 v88, v88, v89
    v_cvt_pk_bf16_f32 v89, v90, v91
    v_cvt_pk_bf16_f32 v90, v92, v93
    v_cvt_pk_bf16_f32 v91, v94, v95
    buffer_store_dwordx4 v[88:91], v112, s[20:23], s36 offen offset:3072 sc1
    s_lshl_b32 s45, s27, 8
    s_lshl_b32 s39, s28, 2
    s_add_u32 s45, s45, s39
    s_add_u32 s45, s45, 25171968
    s_waitcnt vmcnt(0)
    s_barrier
    s_cmp_lg_u32 s25, 0
    s_cbranch_scc1 L_sig13
    v_mov_b32 v4, 0
    v_mov_b32 v5, 1
    s_mov_b64 exec, 1
    s_cmp_eq_u32 s24, 0
    s_cbranch_scc1 L_msg14
    buffer_store_dword v5, v4, s[20:23], s45 offen
    s_branch L_mse15
L_msg14:
    buffer_store_dword v5, v4, s[20:23], s45 offen sc1
L_mse15:
    s_mov_b64 exec, -1
L_sig13:
    s_and_b32 s27, s2, 7
    s_lshl_b32 s27, s27, 2
    s_lshr_b32 s28, s2, 3
    s_and_b32 s28, s28, 3
    s_add_u32 s27, s27, s28
    s_lshr_b32 s28, s2, 5
    s_and_b32 s29, s26, 1
    s_lshr_b32 s30, s26, 1
    s_lshl_b32 s31, s27, 1
    s_add_u32 s31, s31, s30
    s_mov_b32 s56, s14
    s_mov_b32 s57, s15
    s_mov_b32 s58, 0x200000
    s_mov_b32 s59, 0x20000
    v_and_b32 v2, 31, v1
    v_lshrrev_b32 v3, 5, v1
    s_lshl_b32 s37, s28, 1
    s_add_u32 s37, s37, s29
    s_lshl_b32 s40, s30, 12
    s_add_u32 s40, s40, 98304
    v_add_u32 v12, s40, v112
    v_add_u32 v13, 57344, v113
    v_lshlrev_b32 v80, 16, v104
    v_and_b32 v81, 0xffff0000, v104
    v_lshlrev_b32 v82, 16, v105
    v_and_b32 v83, 0xffff0000, v105
    v_lshlrev_b32 v84, 16, v106
    v_and_b32 v85, 0xffff0000, v106
    v_lshlrev_b32 v86, 16, v107
    v_and_b32 v87, 0xffff0000, v107
    v_lshlrev_b32 v88, 16, v108
    v_and_b32 v89, 0xffff0000, v108
    v_lshlrev_b32 v90, 16, v109
    v_and_b32 v91, 0xffff0000, v109
    v_lshlrev_b32 v92, 16, v110
    v_and_b32 v93, 0xffff0000, v110
    v_lshlrev_b32 v94, 16, v111
    v_and_b32 v95, 0xffff0000, v111
    s_lshr_b32 s36, s27, 1
    s_lshl_b32 s36, s36, 8
    s_add_u32 s36, s36, 6144
    s_cmp_lg_u32 s25, 1
    s_cbranch_scc1 L_wp16
    v_and_b32 v7, 15, v1
    v_lshlrev_b32 v7, 2, v7
    v_add_u32 v7, s36, v7
    v_mov_b32 v8, 1
    s_mov_b32 s46, 25165824
    s_mov_b32 s47, 0
L_poll17:
    buffer_load_dword v6, v7, s[20:23], s46 offen sc1
    s_add_u32 s47, s47, 1
    s_waitcnt vmcnt(0)
    v_cmp_gt_u32 vcc, v8, v6
    s_cmp_gt_u32 s47, 262144
    s_cbranch_scc1 L_poll17_out
    s_cbranch_vccnz L_poll17
L_poll17_out:
L_wp16:
    s_barrier
    s_barrier
    s_waitcnt lgkmcnt(0)
    ds_read_b128 v[120:123], v12 offset:0
    ds_read_b64_tr_b16 v[124:125], v113 offset:0
    ds_read_b64_tr_b16 v[126:127], v113 offset:1024
    ds_read_b128 v[128:131], v12 offset:1024
    ds_read_b64_tr_b16 v[132:133], v113 offset:2048
    ds_read_b64_tr_b16 v[134:135], v113 offset:3072
    ds_read_b128 v[136:139], v12 offset:2048
    ds_read_b64_tr_b16 v[140:141], v113 offset:4096
    ds_read_b64_tr_b16 v[142:143], v113 offset:5120
    ds_read_b128 v[144:147], v12 offset:3072
    ds_read_b64_tr_b16 v[148:149], v113 offset:6144
    ds_read_b64_tr_b16 v[150:151], v113 offset:7168
    s_barrier
    ds_read_b128 v[152:155], v12 offset:8192
    ds_read_b64_tr_b16 v[156:157], v113 offset:8192
    ds_read_b64_tr_b16 v[158:159], v113 offset:9216
    s_waitcnt lgkmcnt(12)
    v_mfma_f32_32x32x16_bf16 v[64:79], v[124:127], v[120:123], v[80:95]
    ds_read_b128 v[120:123], v12 offset:9216
    ds_read_b64_tr_b16 v[124:125], v113 offset:10240
    ds_read_b64_tr_b16 v[126:127], v113 offset:11264
    s_waitcnt lgkmcnt(12)
    v_mfma_f32_32x32x16_bf16 v[64:79], v[132:135], v[128:131], v[64:79]
    ds_read_b128 v[128:131], v12 offset:10240
    ds_read_b64_tr_b16 v[132:133], v113 offset:12288
    ds_read_b64_tr_b16 v[134:135], v113 offset:13312
    s_waitcnt lgkmcnt(12)
    v_mfma_f32_32x32x16_bf16 v[64:79], v[140:143], v[136:139], v[64:79]
    ds_read_b128 v[136:139], v12 offset:11264
    ds_read_b64_tr_b16 v[140:141], v113 offset:14336
    ds_read_b64_tr_b16 v[142:143], v113 offset:15360
    s_waitcnt lgkmcnt(12)
    v_mfma_f32_32x32x16_bf16 v[64:79], v[148:151], v[144:147], v[64:79]
    s_barrier
    ds_read_b128 v[144:147], v12 offset:16384
    ds_read_b64_tr_b16 v[148:149], v113 offset:16384
    ds_read_b64_tr_b16 v[150:151], v113 offset:17408
    s_waitcnt lgkmcnt(12)
    v_mfma_f32_32x32x16_bf16 v[64:79], v[156:159], v[152:155], v[64:79]
    ds_read_b128 v[152:155], v12 offset:17408
    ds_read_b64_tr_b16 v[156:157], v113 offset:18432
    ds_read_b64_tr_b16 v[158:159], v113 offset:19456
    s_waitcnt lgkmcnt(12)
    v_mfma_f32_32x32x16_bf16 v[64:79], v[124:127], v[120:123], v[64:79]
    ds_read_b128 v[120:123], v12 offset:18432
    ds_read_b64_tr_b16 v[124:125], v113 offset:20480
    ds_read_b64_tr_b16 v[126:127], v113 offset:21504
    s_waitcnt lgkmcnt(12)
    v_mfma_f32_32x32x16_bf16 v[64:79], v[132:135], v[128:131], v[64:79]
    ds_read_b128 v[128:131], v12 offset:19456
    ds_read_b64_tr_b16 v[132:133], v113 offset:22528
    ds_read_b64_tr_b16 v[134:135], v113 offset:23552
    s_waitcnt lgkmcnt(12)
    v_mfma_f32_32x32x16_bf16 v[64:79], v[140:143], v[136:139], v[64:79]
    s_barrier
    ds_read_b128 v[136:139], v12 offset:24576
    ds_read_b64_tr_b16 v[140:141], v113 offset:24576
    ds_read_b64_tr_b16 v[142:143], v113 offset:25600
    s_waitcnt lgkmcnt(12)
    v_mfma_f32_32x32x16_bf16 v[64:79], v[148:151], v[144:147], v[64:79]
    ds_read_b128 v[144:147], v12 offset:25600
    ds_read_b64_tr_b16 v[148:149], v113 offset:26624
    ds_read_b64_tr_b16 v[150:151], v113 offset:27648
    s_waitcnt lgkmcnt(12)
    v_mfma_f32_32x32x16_bf16 v[64:79], v[156:159], v[152:155], v[64:79]
    ds_read_b128 v[152:155], v12 offset:26624
    ds_read_b64_tr_b16 v[156:157], v113 offset:28672
    ds_read_b64_tr_b16 v[158:159], v113 offset:29696
    s_waitcnt lgkmcnt(12)
    v_mfma_f32_32x32x16_bf16 v[64:79], v[124:127], v[120:123], v[64:79]
    ds_read_b128 v[120:123], v12 offset:27648
    ds_read_b64_tr_b16 v[124:125], v113 offset:30720
    ds_read_b64_tr_b16 v[126:127], v113 offset:31744
    s_waitcnt lgkmcnt(12)
    v_mfma_f32_32x32x16_bf16 v[64:79], v[132:135], v[128:131], v[64:79]
    s_barrier
    ds_read_b128 v[128:131], v12 offset:32768
    ds_read_b64_tr_b16 v[132:133], v113 offset:32768
    ds_read_b64_tr_b16 v[134:135], v113 offset:33792
    s_waitcnt lgkmcnt(12)
    v_mfma_f32_32x32x16_bf16 v[64:79], v[140:143], v[136:139], v[64:79]
    ds_read_b128 v[136:139], v12 offset:33792
    ds_read_b64_tr_b16 v[140:141], v113 offset:34816
    ds_read_b64_tr_b16 v[142:143], v113 offset:35840
    s_waitcnt lgkmcnt(12)
    v_mfma_f32_32x32x16_bf16 v[64:79], v[148:151], v[144:147], v[64:79]
    ds_read_b128 v[144:147], v12 offset:34816
    ds_read_b64_tr_b16 v[148:149], v113 offset:36864
    ds_read_b64_tr_b16 v[150:151], v113 offset:37888
    s_waitcnt lgkmcnt(12)
    v_mfma_f32_32x32x16_bf16 v[64:79], v[156:159], v[152:155], v[64:79]
    ds_read_b128 v[152:155], v12 offset:35840
    ds_read_b64_tr_b16 v[156:157], v113 offset:38912
    ds_read_b64_tr_b16 v[158:159], v113 offset:39936
    s_waitcnt lgkmcnt(12)
    v_mfma_f32_32x32x16_bf16 v[64:79], v[124:127], v[120:123], v[64:79]
    s_barrier
    ds_read_b128 v[120:123], v12 offset:40960
    ds_read_b64_tr_b16 v[124:125], v113 offset:40960
    ds_read_b64_tr_b16 v[126:127], v113 offset:41984
    s_waitcnt lgkmcnt(12)
    v_mfma_f32_32x32x16_bf16 v[64:79], v[132:135], v[128:131], v[64:79]
    ds_read_b128 v[128:131], v12 offset:41984
    ds_read_b64_tr_b16 v[132:133], v113 offset:43008
    ds_read_b64_tr_b16 v[134:135], v113 offset:44032
    s_waitcnt lgkmcnt(12)
    v_mfma_f32_32x32x16_bf16 v[64:79], v[140:143], v[136:139], v[64:79]
    ds_read_b128 v[136:139], v12 offset:43008
    ds_read_b64_tr_b16 v[140:141], v113 offset:45056
    ds_read_b64_tr_b16 v[142:143], v113 offset:46080
    s_waitcnt lgkmcnt(12)
    v_mfma_f32_32x32x16_bf16 v[64:79], v[148:151], v[144:147], v[64:79]
    ds_read_b128 v[144:147], v12 offset:44032
    ds_read_b64_tr_b16 v[148:149], v113 offset:47104
    ds_read_b64_tr_b16 v[150:151], v113 offset:48128
    s_waitcnt lgkmcnt(12)
    v_mfma_f32_32x32x16_bf16 v[64:79], v[156:159], v[152:155], v[64:79]
    s_barrier
    ds_read_b128 v[152:155], v12 offset:49152
    ds_read_b64_tr_b16 v[156:157], v113 offset:49152
    ds_read_b64_tr_b16 v[158:159], v113 offset:50176
    s_waitcnt lgkmcnt(12)
    v_mfma_f32_32x32x16_bf16 v[64:79], v[124:127], v[120:123], v[64:79]
    ds_read_b128 v[120:123], v12 offset:50176
    ds_read_b64_tr_b16 v[124:125], v113 offset:51200
    ds_read_b64_tr_b16 v[126:127], v113 offset:52224
    s_waitcnt lgkmcnt(12)
    v_mfma_f32_32x32x16_bf16 v[64:79], v[132:135], v[128:131], v[64:79]
    ds_read_b128 v[128:131], v12 offset:51200
    ds_read_b64_tr_b16 v[132:133], v113 offset:53248
    ds_read_b64_tr_b16 v[134:135], v113 offset:54272
    s_waitcnt lgkmcnt(12)
    v_mfma_f32_32x32x16_bf16 v[64:79], v[140:143], v[136:139], v[64:79]
    ds_read_b128 v[136:139], v12 offset:52224
    ds_read_b64_tr_b16 v[140:141], v113 offset:55296
    ds_read_b64_tr_b16 v[142:143], v113 offset:56320
    s_waitcnt lgkmcnt(12)
    v_mfma_f32_32x32x16_bf16 v[64:79], v[148:151], v[144:147], v[64:79]
    s_barrier
    ds_read_b128 v[144:147], v12 offset:57344
    ds_read_b64_tr_b16 v[148:149], v13 offset:0
    ds_read_b64_tr_b16 v[150:151], v13 offset:1024
    s_waitcnt lgkmcnt(12)
    v_mfma_f32_32x32x16_bf16 v[64:79], v[156:159], v[152:155], v[64:79]
    ds_read_b128 v[152:155], v12 offset:58368
    ds_read_b64_tr_b16 v[156:157], v13 offset:2048
    ds_read_b64_tr_b16 v[158:159], v13 offset:3072
    s_waitcnt lgkmcnt(12)
    v_mfma_f32_32x32x16_bf16 v[64:79], v[124:127], v[120:123], v[64:79]
    ds_read_b128 v[120:123], v12 offset:59392
    ds_read_b64_tr_b16 v[124:125], v13 offset:4096
    ds_read_b64_tr_b16 v[126:127], v13 offset:5120
    s_waitcnt lgkmcnt(12)
    v_mfma_f32_32x32x16_bf16 v[64:79], v[132:135], v[128:131], v[64:79]
    ds_read_b128 v[128:131], v12 offset:60416
    ds_read_b64_tr_b16 v[132:133], v13 offset:6144
    ds_read_b64_tr_b16 v[134:135], v13 offset:7168
    s_waitcnt lgkmcnt(12)
    v_mfma_f32_32x32x16_bf16 v[64:79], v[140:143], v[136:139], v[64:79]
    s_barrier
    ds_read_b128 v[136:139], v12 offset:0
    ds_read_b64_tr_b16 v[140:141], v13 offset:8192
    ds_read_b64_tr_b16 v[142:143], v13 offset:9216
    s_waitcnt lgkmcnt(12)
    v_mfma_f32_32x32x16_bf16 v[64:79], v[148:151], v[144:147], v[64:79]
    ds_read_b128 v[144:147], v12 offset:1024
    ds_read_b64_tr_b16 v[148:149], v13 offset:10240
    ds_read_b64_tr_b16 v[150:151], v13 offset:11264
    s_waitcnt lgkmcnt(12)
    v_mfma_f32_32x32x16_bf16 v[64:79], v[156:159], v[152:155], v[64:79]
    ds_read_b128 v[152:155], v12 offset:2048
    ds_read_b64_tr_b16 v[156:157], v13 offset:12288
    ds_read_b64_tr_b16 v[158:159], v13 offset:13312
    s_waitcnt lgkmcnt(12)
    v_mfma_f32_32x32x16_bf16 v[64:79], v[124:127], v[120:123], v[64:79]
    ds_read_b128 v[120:123], v12 offset:3072
    ds_read_b64_tr_b16 v[124:125], v13 offset:14336
    ds_read_b64_tr_b16 v[126:127], v13 offset:15360
    s_waitcnt lgkmcnt(12)
    v_mfma_f32_32x32x16_bf16 v[64:79], v[132:135], v[128:131], v[64:79]
    s_barrier
    ds_read_b128 v[128:131], v12 offset:8192
    ds_read_b64_tr_b16 v[132:133], v13 offset:16384
    ds_read_b64_tr_b16 v[134:135], v13 offset:17408
    s_waitcnt lgkmcnt(12)
    v_mfma_f32_32x32x16_bf16 v[64:79], v[140:143], v[136:139], v[64:79]
    ds_read_b128 v[136:139], v12 offset:9216
    ds_read_b64_tr_b16 v[140:141], v13 offset:18432
    ds_read_b64_tr_b16 v[142:143], v13 offset:19456
    s_waitcnt lgkmcnt(12)
    v_mfma_f32_32x32x16_bf16 v[64:79], v[148:151], v[144:147], v[64:79]
    ds_read_b128 v[144:147], v12 offset:10240
    ds_read_b64_tr_b16 v[148:149], v13 offset:20480
    ds_read_b64_tr_b16 v[150:151], v13 offset:21504
    s_waitcnt lgkmcnt(12)
    v_mfma_f32_32x32x16_bf16 v[64:79], v[156:159], v[152:155], v[64:79]
    ds_read_b128 v[152:155], v12 offset:11264
    ds_read_b64_tr_b16 v[156:157], v13 offset:22528
    ds_read_b64_tr_b16 v[158:159], v13 offset:23552
    s_waitcnt lgkmcnt(12)
    v_mfma_f32_32x32x16_bf16 v[64:79], v[124:127], v[120:123], v[64:79]
    s_barrier
    ds_read_b128 v[120:123], v12 offset:16384
    ds_read_b64_tr_b16 v[124:125], v13 offset:24576
    ds_read_b64_tr_b16 v[126:127], v13 offset:25600
    s_waitcnt lgkmcnt(12)
    v_mfma_f32_32x32x16_bf16 v[64:79], v[132:135], v[128:131], v[64:79]
    ds_read_b128 v[128:131], v12 offset:17408
    ds_read_b64_tr_b16 v[132:133], v13 offset:26624
    ds_read_b64_tr_b16 v[134:135], v13 offset:27648
    s_waitcnt lgkmcnt(12)
    v_mfma_f32_32x32x16_bf16 v[64:79], v[140:143], v[136:139], v[64:79]
    ds_read_b128 v[136:139], v12 offset:18432
    ds_read_b64_tr_b16 v[140:141], v13 offset:28672
    ds_read_b64_tr_b16 v[142:143], v13 offset:29696
    s_waitcnt lgkmcnt(12)
    v_mfma_f32_32x32x16_bf16 v[64:79], v[148:151], v[144:147], v[64:79]
    ds_read_b128 v[144:147], v12 offset:19456
    ds_read_b64_tr_b16 v[148:149], v13 offset:30720
    ds_read_b64_tr_b16 v[150:151], v13 offset:31744
    s_waitcnt lgkmcnt(12)
    v_mfma_f32_32x32x16_bf16 v[64:79], v[156:159], v[152:155], v[64:79]
    s_barrier
    ds_read_b128 v[152:155], v12 offset:24576
    ds_read_b64_tr_b16 v[156:157], v13 offset:32768
    ds_read_b64_tr_b16 v[158:159], v13 offset:33792
    s_waitcnt lgkmcnt(12)
    v_mfma_f32_32x32x16_bf16 v[64:79], v[124:127], v[120:123], v[64:79]
    ds_read_b128 v[120:123], v12 offset:25600
    ds_read_b64_tr_b16 v[124:125], v13 offset:34816
    ds_read_b64_tr_b16 v[126:127], v13 offset:35840
    s_waitcnt lgkmcnt(12)
    v_mfma_f32_32x32x16_bf16 v[64:79], v[132:135], v[128:131], v[64:79]
    ds_read_b128 v[128:131], v12 offset:26624
    ds_read_b64_tr_b16 v[132:133], v13 offset:36864
    ds_read_b64_tr_b16 v[134:135], v13 offset:37888
    s_waitcnt lgkmcnt(12)
    v_mfma_f32_32x32x16_bf16 v[64:79], v[140:143], v[136:139], v[64:79]
    ds_read_b128 v[136:139], v12 offset:27648
    ds_read_b64_tr_b16 v[140:141], v13 offset:38912
    ds_read_b64_tr_b16 v[142:143], v13 offset:39936
    s_waitcnt lgkmcnt(12)
    v_mfma_f32_32x32x16_bf16 v[64:79], v[148:151], v[144:147], v[64:79]
    s_barrier
    ds_read_b128 v[144:147], v12 offset:32768
    ds_read_b64_tr_b16 v[148:149], v113 offset:0
    ds_read_b64_tr_b16 v[150:151], v113 offset:1024
    s_waitcnt lgkmcnt(12)
    v_mfma_f32_32x32x16_bf16 v[64:79], v[156:159], v[152:155], v[64:79]
    ds_read_b128 v[152:155], v12 offset:33792
    ds_read_b64_tr_b16 v[156:157], v113 offset:2048
    ds_read_b64_tr_b16 v[158:159], v113 offset:3072
    s_waitcnt lgkmcnt(12)
    v_mfma_f32_32x32x16_bf16 v[64:79], v[124:127], v[120:123], v[64:79]
    ds_read_b128 v[120:123], v12 offset:34816
    ds_read_b64_tr_b16 v[124:125], v113 offset:4096
    ds_read_b64_tr_b16 v[126:127], v113 offset:5120
    s_waitcnt lgkmcnt(12)
    v_mfma_f32_32x32x16_bf16 v[64:79], v[132:135], v[128:131], v[64:79]
    ds_read_b128 v[128:131], v12 offset:35840
    ds_read_b64_tr_b16 v[132:133], v113 offset:6144
    ds_read_b64_tr_b16 v[134:135], v113 offset:7168
    s_waitcnt lgkmcnt(12)
    v_mfma_f32_32x32x16_bf16 v[64:79], v[140:143], v[136:139], v[64:79]
    s_barrier
    ds_read_b128 v[136:139], v12 offset:40960
    ds_read_b64_tr_b16 v[140:141], v113 offset:8192
    ds_read_b64_tr_b16 v[142:143], v113 offset:9216
    s_waitcnt lgkmcnt(12)
    v_mfma_f32_32x32x16_bf16 v[64:79], v[148:151], v[144:147], v[64:79]
    ds_read_b128 v[144:147], v12 offset:41984
    ds_read_b64_tr_b16 v[148:149], v113 offset:10240
    ds_read_b64_tr_b16 v[150:151], v113 offset:11264
    s_waitcnt lgkmcnt(12)
    v_mfma_f32_32x32x16_bf16 v[64:79], v[156:159], v[152:155], v[64:79]
    ds_read_b128 v[152:155], v12 offset:43008
    ds_read_b64_tr_b16 v[156:157], v113 offset:12288
    ds_read_b64_tr_b16 v[158:159], v113 offset:13312
    s_waitcnt lgkmcnt(12)
    v_mfma_f32_32x32x16_bf16 v[64:79], v[124:127], v[120:123], v[64:79]
    ds_read_b128 v[120:123], v12 offset:44032
    ds_read_b64_tr_b16 v[124:125], v113 offset:14336
    ds_read_b64_tr_b16 v[126:127], v113 offset:15360
    s_waitcnt lgkmcnt(12)
    v_mfma_f32_32x32x16_bf16 v[64:79], v[132:135], v[128:131], v[64:79]
    s_barrier
    ds_read_b128 v[128:131], v12 offset:49152
    ds_read_b64_tr_b16 v[132:133], v113 offset:16384
    ds_read_b64_tr_b16 v[134:135], v113 offset:17408
    s_waitcnt lgkmcnt(12)
    v_mfma_f32_32x32x16_bf16 v[64:79], v[140:143], v[136:139], v[64:79]
    ds_read_b128 v[136:139], v12 offset:50176
    ds_read_b64_tr_b16 v[140:141], v113 offset:18432
    ds_read_b64_tr_b16 v[142:143], v113 offset:19456
    s_waitcnt lgkmcnt(12)
    v_mfma_f32_32x32x16_bf16 v[64:79], v[148:151], v[144:147], v[64:79]
    ds_read_b128 v[144:147], v12 offset:51200
    ds_read_b64_tr_b16 v[148:149], v113 offset:20480
    ds_read_b64_tr_b16 v[150:151], v113 offset:21504
    s_waitcnt lgkmcnt(12)
    v_mfma_f32_32x32x16_bf16 v[64:79], v[156:159], v[152:155], v[64:79]
    ds_read_b128 v[152:155], v12 offset:52224
    ds_read_b64_tr_b16 v[156:157], v113 offset:22528
    ds_read_b64_tr_b16 v[158:159], v113 offset:23552
    s_waitcnt lgkmcnt(12)
    v_mfma_f32_32x32x16_bf16 v[64:79], v[124:127], v[120:123], v[64:79]
    s_barrier
    ds_read_b128 v[120:123], v12 offset:57344
    ds_read_b64_tr_b16 v[124:125], v113 offset:24576
    ds_read_b64_tr_b16 v[126:127], v113 offset:25600
    s_waitcnt lgkmcnt(12)
    v_mfma_f32_32x32x16_bf16 v[64:79], v[132:135], v[128:131], v[64:79]
    ds_read_b128 v[128:131], v12 offset:58368
    ds_read_b64_tr_b16 v[132:133], v113 offset:26624
    ds_read_b64_tr_b16 v[134:135], v113 offset:27648
    s_waitcnt lgkmcnt(12)
    v_mfma_f32_32x32x16_bf16 v[64:79], v[140:143], v[136:139], v[64:79]
    ds_read_b128 v[136:139], v12 offset:59392
    ds_read_b64_tr_b16 v[140:141], v113 offset:28672
    ds_read_b64_tr_b16 v[142:143], v113 offset:29696
    s_waitcnt lgkmcnt(12)
    v_mfma_f32_32x32x16_bf16 v[64:79], v[148:151], v[144:147], v[64:79]
    ds_read_b128 v[144:147], v12 offset:60416
    ds_read_b64_tr_b16 v[148:149], v113 offset:30720
    ds_read_b64_tr_b16 v[150:151], v113 offset:31744
    s_waitcnt lgkmcnt(12)
    v_mfma_f32_32x32x16_bf16 v[64:79], v[156:159], v[152:155], v[64:79]
    s_barrier
    ds_read_b128 v[152:155], v12 offset:0
    ds_read_b64_tr_b16 v[156:157], v113 offset:32768
    ds_read_b64_tr_b16 v[158:159], v113 offset:33792
    s_waitcnt lgkmcnt(12)
    v_mfma_f32_32x32x16_bf16 v[64:79], v[124:127], v[120:123], v[64:79]
    ds_read_b128 v[120:123], v12 offset:1024
    ds_read_b64_tr_b16 v[124:125], v113 offset:34816
    ds_read_b64_tr_b16 v[126:127], v113 offset:35840
    s_waitcnt lgkmcnt(12)
    v_mfma_f32_32x32x16_bf16 v[64:79], v[132:135], v[128:131], v[64:79]
    ds_read_b128 v[128:131], v12 offset:2048
    ds_read_b64_tr_b16 v[132:133], v113 offset:36864
    ds_read_b64_tr_b16 v[134:135], v113 offset:37888
    s_waitcnt lgkmcnt(12)
    v_mfma_f32_32x32x16_bf16 v[64:79], v[140:143], v[136:139], v[64:79]
    ds_read_b128 v[136:139], v12 offset:3072
    ds_read_b64_tr_b16 v[140:141], v113 offset:38912
    ds_read_b64_tr_b16 v[142:143], v113 offset:39936
    s_waitcnt lgkmcnt(12)
    v_mfma_f32_32x32x16_bf16 v[64:79], v[148:151], v[144:147], v[64:79]
    s_barrier
    ds_read_b128 v[144:147], v12 offset:8192
    ds_read_b64_tr_b16 v[148:149], v113 offset:40960
    ds_read_b64_tr_b16 v[150:151], v113 offset:41984
    s_waitcnt lgkmcnt(12)
    v_mfma_f32_32x32x16_bf16 v[64:79], v[156:159], v[152:155], v[64:79]
    ds_read_b128 v[152:155], v12 offset:9216
    ds_read_b64_tr_b16 v[156:157], v113 offset:43008
    ds_read_b64_tr_b16 v[158:159], v113 offset:44032
    s_waitcnt lgkmcnt(12)
    v_mfma_f32_32x32x16_bf16 v[64:79], v[124:127], v[120:123], v[64:79]
    ds_read_b128 v[120:123], v12 offset:10240
    ds_read_b64_tr_b16 v[124:125], v113 offset:45056
    ds_read_b64_tr_b16 v[126:127], v113 offset:46080
    s_waitcnt lgkmcnt(12)
    v_mfma_f32_32x32x16_bf16 v[64:79], v[132:135], v[128:131], v[64:79]
    ds_read_b128 v[128:131], v12 offset:11264
    ds_read_b64_tr_b16 v[132:133], v113 offset:47104
    ds_read_b64_tr_b16 v[134:135], v113 offset:48128
    s_waitcnt lgkmcnt(12)
    v_mfma_f32_32x32x16_bf16 v[64:79], v[140:143], v[136:139], v[64:79]
    s_barrier
    ds_read_b128 v[136:139], v12 offset:16384
    ds_read_b64_tr_b16 v[140:141], v113 offset:49152
    ds_read_b64_tr_b16 v[142:143], v113 offset:50176
    s_waitcnt lgkmcnt(12)
    v_mfma_f32_32x32x16_bf16 v[64:79], v[148:151], v[144:147], v[64:79]
    ds_read_b128 v[144:147], v12 offset:17408
    ds_read_b64_tr_b16 v[148:149], v113 offset:51200
    ds_read_b64_tr_b16 v[150:151], v113 offset:52224
    s_waitcnt lgkmcnt(12)
    v_mfma_f32_32x32x16_bf16 v[64:79], v[156:159], v[152:155], v[64:79]
    ds_read_b128 v[152:155], v12 offset:18432
    ds_read_b64_tr_b16 v[156:157], v113 offset:53248
    ds_read_b64_tr_b16 v[158:159], v113 offset:54272
    s_waitcnt lgkmcnt(12)
    v_mfma_f32_32x32x16_bf16 v[64:79], v[124:127], v[120:123], v[64:79]
    ds_read_b128 v[120:123], v12 offset:19456
    ds_read_b64_tr_b16 v[124:125], v113 offset:55296
    ds_read_b64_tr_b16 v[126:127], v113 offset:56320
    s_waitcnt lgkmcnt(12)
    v_mfma_f32_32x32x16_bf16 v[64:79], v[132:135], v[128:131], v[64:79]
    s_barrier
    ds_read_b128 v[128:131], v12 offset:24576
    ds_read_b64_tr_b16 v[132:133], v13 offset:0
    ds_read_b64_tr_b16 v[134:135], v13 offset:1024
    s_waitcnt lgkmcnt(12)
    v_mfma_f32_32x32x16_bf16 v[64:79], v[140:143], v[136:139], v[64:79]
    ds_read_b128 v[136:139], v12 offset:25600
    ds_read_b64_tr_b16 v[140:141], v13 offset:2048
    ds_read_b64_tr_b16 v[142:143], v13 offset:3072
    s_waitcnt lgkmcnt(12)
    v_mfma_f32_32x32x16_bf16 v[64:79], v[148:151], v[144:147], v[64:79]
    ds_read_b128 v[144:147], v12 offset:26624
    ds_read_b64_tr_b16 v[148:149], v13 offset:4096
    ds_read_b64_tr_b16 v[150:151], v13 offset:5120
    s_waitcnt lgkmcnt(12)
    v_mfma_f32_32x32x16_bf16 v[64:79], v[156:159], v[152:155], v[64:79]
    ds_read_b128 v[152:155], v12 offset:27648
    ds_read_b64_tr_b16 v[156:157], v13 offset:6144
    ds_read_b64_tr_b16 v[158:159], v13 offset:7168
    s_waitcnt lgkmcnt(12)
    v_mfma_f32_32x32x16_bf16 v[64:79], v[124:127], v[120:123], v[64:79]
    s_barrier
    ds_read_b128 v[120:123], v12 offset:32768
    ds_read_b64_tr_b16 v[124:125], v13 offset:8192
    ds_read_b64_tr_b16 v[126:127], v13 offset:9216
    s_waitcnt lgkmcnt(12)
    v_mfma_f32_32x32x16_bf16 v[64:79], v[132:135], v[128:131], v[64:79]
    ds_read_b128 v[128:131], v12 offset:33792
    ds_read_b64_tr_b16 v[132:133], v13 offset:10240
    ds_read_b64_tr_b16 v[134:135], v13 offset:11264
    s_waitcnt lgkmcnt(12)
    v_mfma_f32_32x32x16_bf16 v[64:79], v[140:143], v[136:139], v[64:79]
    ds_read_b128 v[136:139], v12 offset:34816
    ds_read_b64_tr_b16 v[140:141], v13 offset:12288
    ds_read_b64_tr_b16 v[142:143], v13 offset:13312
    s_waitcnt lgkmcnt(12)
    v_mfma_f32_32x32x16_bf16 v[64:79], v[148:151], v[144:147], v[64:79]
    ds_read_b128 v[144:147], v12 offset:35840
    ds_read_b64_tr_b16 v[148:149], v13 offset:14336
    ds_read_b64_tr_b16 v[150:151], v13 offset:15360
    s_waitcnt lgkmcnt(12)
    v_mfma_f32_32x32x16_bf16 v[64:79], v[156:159], v[152:155], v[64:79]
    s_barrier
    ds_read_b128 v[152:155], v12 offset:40960
    ds_read_b64_tr_b16 v[156:157], v13 offset:16384
    ds_read_b64_tr_b16 v[158:159], v13 offset:17408
    s_waitcnt lgkmcnt(12)
    v_mfma_f32_32x32x16_bf16 v[64:79], v[124:127], v[120:123], v[64:79]
    ds_read_b128 v[120:123], v12 offset:41984
    ds_read_b64_tr_b16 v[124:125], v13 offset:18432
    ds_read_b64_tr_b16 v[126:127], v13 offset:19456
    s_waitcnt lgkmcnt(12)
    v_mfma_f32_32x32x16_bf16 v[64:79], v[132:135], v[128:131], v[64:79]
    ds_read_b128 v[128:131], v12 offset:43008
    ds_read_b64_tr_b16 v[132:133], v13 offset:20480
    ds_read_b64_tr_b16 v[134:135], v13 offset:21504
    s_waitcnt lgkmcnt(12)
    v_mfma_f32_32x32x16_bf16 v[64:79], v[140:143], v[136:139], v[64:79]
    ds_read_b128 v[136:139], v12 offset:44032
    ds_read_b64_tr_b16 v[140:141], v13 offset:22528
    ds_read_b64_tr_b16 v[142:143], v13 offset:23552
    s_waitcnt lgkmcnt(12)
    v_mfma_f32_32x32x16_bf16 v[64:79], v[148:151], v[144:147], v[64:79]
    s_barrier
    ds_read_b128 v[144:147], v12 offset:49152
    ds_read_b64_tr_b16 v[148:149], v13 offset:24576
    ds_read_b64_tr_b16 v[150:151], v13 offset:25600
    s_waitcnt lgkmcnt(12)
    v_mfma_f32_32x32x16_bf16 v[64:79], v[156:159], v[152:155], v[64:79]
    ds_read_b128 v[152:155], v12 offset:50176
    ds_read_b64_tr_b16 v[156:157], v13 offset:26624
    ds_read_b64_tr_b16 v[158:159], v13 offset:27648
    s_waitcnt lgkmcnt(12)
    v_mfma_f32_32x32x16_bf16 v[64:79], v[124:127], v[120:123], v[64:79]
    ds_read_b128 v[120:123], v12 offset:51200
    ds_read_b64_tr_b16 v[124:125], v13 offset:28672
    ds_read_b64_tr_b16 v[126:127], v13 offset:29696
    s_waitcnt lgkmcnt(12)
    v_mfma_f32_32x32x16_bf16 v[64:79], v[132:135], v[128:131], v[64:79]
    ds_read_b128 v[128:131], v12 offset:52224
    ds_read_b64_tr_b16 v[132:133], v13 offset:30720
    ds_read_b64_tr_b16 v[134:135], v13 offset:31744
    s_waitcnt lgkmcnt(12)
    v_mfma_f32_32x32x16_bf16 v[64:79], v[140:143], v[136:139], v[64:79]
    s_barrier
    ds_read_b128 v[136:139], v12 offset:57344
    ds_read_b64_tr_b16 v[140:141], v13 offset:32768
    ds_read_b64_tr_b16 v[142:143], v13 offset:33792
    s_waitcnt lgkmcnt(12)
    v_mfma_f32_32x32x16_bf16 v[64:79], v[148:151], v[144:147], v[64:79]
    ds_read_b128 v[144:147], v12 offset:58368
    ds_read_b64_tr_b16 v[148:149], v13 offset:34816
    ds_read_b64_tr_b16 v[150:151], v13 offset:35840
    s_waitcnt lgkmcnt(12)
    v_mfma_f32_32x32x16_bf16 v[64:79], v[156:159], v[152:155], v[64:79]
    ds_read_b128 v[152:155], v12 offset:59392
    ds_read_b64_tr_b16 v[156:157], v13 offset:36864
    ds_read_b64_tr_b16 v[158:159], v13 offset:37888
    s_waitcnt lgkmcnt(12)
    v_mfma_f32_32x32x16_bf16 v[64:79], v[124:127], v[120:123], v[64:79]
    ds_read_b128 v[120:123], v12 offset:60416
    ds_read_b64_tr_b16 v[124:125], v13 offset:38912
    ds_read_b64_tr_b16 v[126:127], v13 offset:39936
    s_waitcnt lgkmcnt(12)
    v_mfma_f32_32x32x16_bf16 v[64:79], v[132:135], v[128:131], v[64:79]
    s_barrier
    ds_read_b128 v[128:131], v12 offset:0
    ds_read_b64_tr_b16 v[132:133], v113 offset:0
    ds_read_b64_tr_b16 v[134:135], v113 offset:1024
    s_waitcnt lgkmcnt(12)
    v_mfma_f32_32x32x16_bf16 v[64:79], v[140:143], v[136:139], v[64:79]
    ds_read_b128 v[136:139], v12 offset:1024
    ds_read_b64_tr_b16 v[140:141], v113 offset:2048
    ds_read_b64_tr_b16 v[142:143], v113 offset:3072
    s_waitcnt lgkmcnt(12)
    v_mfma_f32_32x32x16_bf16 v[64:79], v[148:151], v[144:147], v[64:79]
    ds_read_b128 v[144:147], v12 offset:2048
    ds_read_b64_tr_b16 v[148:149], v113 offset:4096
    ds_read_b64_tr_b16 v[150:151], v113 offset:5120
    s_waitcnt lgkmcnt(12)
    v_mfma_f32_32x32x16_bf16 v[64:79], v[156:159], v[152:155], v[64:79]
    ds_read_b128 v[152:155], v12 offset:3072
    ds_read_b64_tr_b16 v[156:157], v113 offset:6144
    ds_read_b64_tr_b16 v[158:159], v113 offset:7168
    s_waitcnt lgkmcnt(12)
    v_mfma_f32_32x32x16_bf16 v[64:79], v[124:127], v[120:123], v[64:79]
    s_barrier
    ds_read_b128 v[120:123], v12 offset:8192
    ds_read_b64_tr_b16 v[124:125], v113 offset:8192
    ds_read_b64_tr_b16 v[126:127], v113 offset:9216
    s_waitcnt lgkmcnt(12)
    v_mfma_f32_32x32x16_bf16 v[64:79], v[132:135], v[128:131], v[64:79]
    ds_read_b128 v[128:131], v12 offset:9216
    ds_read_b64_tr_b16 v[132:133], v113 offset:10240
    ds_read_b64_tr_b16 v[134:135], v113 offset:11264
    s_waitcnt lgkmcnt(12)
    v_mfma_f32_32x32x16_bf16 v[64:79], v[140:143], v[136:139], v[64:79]
    ds_read_b128 v[136:139], v12 offset:10240
    ds_read_b64_tr_b16 v[140:141], v113 offset:12288
    ds_read_b64_tr_b16 v[142:143], v113 offset:13312
    s_waitcnt lgkmcnt(12)
    v_mfma_f32_32x32x16_bf16 v[64:79], v[148:151], v[144:147], v[64:79]
    ds_read_b128 v[144:147], v12 offset:11264
    ds_read_b64_tr_b16 v[148:149], v113 offset:14336
    ds_read_b64_tr_b16 v[150:151], v113 offset:15360
    s_waitcnt lgkmcnt(12)
    v_mfma_f32_32x32x16_bf16 v[64:79], v[156:159], v[152:155], v[64:79]
    s_barrier
    ds_read_b128 v[152:155], v12 offset:16384
    ds_read_b64_tr_b16 v[156:157], v113 offset:16384
    ds_read_b64_tr_b16 v[158:159], v113 offset:17408
    s_waitcnt lgkmcnt(12)
    v_mfma_f32_32x32x16_bf16 v[64:79], v[124:127], v[120:123], v[64:79]
    ds_read_b128 v[120:123], v12 offset:17408
    ds_read_b64_tr_b16 v[124:125], v113 offset:18432
    ds_read_b64_tr_b16 v[126:127], v113 offset:19456
    s_waitcnt lgkmcnt(12)
    v_mfma_f32_32x32x16_bf16 v[64:79], v[132:135], v[128:131], v[64:79]
    ds_read_b128 v[128:131], v12 offset:18432
    ds_read_b64_tr_b16 v[132:133], v113 offset:20480
    ds_read_b64_tr_b16 v[134:135], v113 offset:21504
    s_waitcnt lgkmcnt(12)
    v_mfma_f32_32x32x16_bf16 v[64:79], v[140:143], v[136:139], v[64:79]
    ds_read_b128 v[136:139], v12 offset:19456
    ds_read_b64_tr_b16 v[140:141], v113 offset:22528
    ds_read_b64_tr_b16 v[142:143], v113 offset:23552
    s_waitcnt lgkmcnt(12)
    v_mfma_f32_32x32x16_bf16 v[64:79], v[148:151], v[144:147], v[64:79]
    s_barrier
    ds_read_b128 v[144:147], v12 offset:24576
    ds_read_b64_tr_b16 v[148:149], v113 offset:24576
    ds_read_b64_tr_b16 v[150:151], v113 offset:25600
    s_waitcnt lgkmcnt(12)
    v_mfma_f32_32x32x16_bf16 v[64:79], v[156:159], v[152:155], v[64:79]
    ds_read_b128 v[152:155], v12 offset:25600
    ds_read_b64_tr_b16 v[156:157], v113 offset:26624
    ds_read_b64_tr_b16 v[158:159], v113 offset:27648
    s_waitcnt lgkmcnt(12)
    v_mfma_f32_32x32x16_bf16 v[64:79], v[124:127], v[120:123], v[64:79]
    ds_read_b128 v[120:123], v12 offset:26624
    ds_read_b64_tr_b16 v[124:125], v113 offset:28672
    ds_read_b64_tr_b16 v[126:127], v113 offset:29696
    s_waitcnt lgkmcnt(12)
    v_mfma_f32_32x32x16_bf16 v[64:79], v[132:135], v[128:131], v[64:79]
    ds_read_b128 v[128:131], v12 offset:27648
    ds_read_b64_tr_b16 v[132:133], v113 offset:30720
    ds_read_b64_tr_b16 v[134:135], v113 offset:31744
    s_waitcnt lgkmcnt(12)
    v_mfma_f32_32x32x16_bf16 v[64:79], v[140:143], v[136:139], v[64:79]
    s_waitcnt lgkmcnt(9)
    v_mfma_f32_32x32x16_bf16 v[64:79], v[148:151], v[144:147], v[64:79]
    s_waitcnt lgkmcnt(6)
    v_mfma_f32_32x32x16_bf16 v[64:79], v[156:159], v[152:155], v[64:79]
    s_waitcnt lgkmcnt(3)
    v_mfma_f32_32x32x16_bf16 v[64:79], v[124:127], v[120:123], v[64:79]
    s_waitcnt lgkmcnt(0)
    v_mfma_f32_32x32x16_bf16 v[64:79], v[132:135], v[128:131], v[64:79]
    s_nop 11
    v_cvt_pk_bf16_f32 v64, v64, v65
    v_cvt_pk_bf16_f32 v65, v66, v67
    v_cvt_pk_bf16_f32 v66, v68, v69
    v_cvt_pk_bf16_f32 v67, v70, v71
    v_cvt_pk_bf16_f32 v68, v72, v73
    v_cvt_pk_bf16_f32 v69, v74, v75
    v_cvt_pk_bf16_f32 v70, v76, v77
    v_cvt_pk_bf16_f32 v71, v78, v79
    v_lshlrev_b32 v4, 10, v2
    v_lshl_add_u32 v4, v3, 4, v4
    v_permlane32_swap_b32 v64, v66
    v_permlane32_swap_b32 v65, v67
    v_permlane32_swap_b32 v68, v70
    v_permlane32_swap_b32 v69, v71
    s_lshl_b32 s38, s31, 15
    s_lshl_b32 s39, s37, 6
    s_add_u32 s38, s38, s39
    buffer_store_dwordx4 v[64:67], v4, s[56:59], s38 offen
    buffer_store_dwordx4 v[68:71], v4, s[56:59], s38 offen offset:32
L_end:
    s_endpgm
L_codeend:
    s_nop 0

.section .rodata,"a"
.p2align 6
.amdhsa_kernel sequential_preLN__softmax_full_mha__swiglu_ffn__prompt_kernel
  .amdhsa_next_free_vgpr 192
  .amdhsa_next_free_sgpr 68
  .amdhsa_accum_offset 192
  .amdhsa_group_segment_fixed_size 0
  .amdhsa_kernarg_size 80
  .amdhsa_user_sgpr_count 2
  .amdhsa_user_sgpr_kernarg_segment_ptr 1
  .amdhsa_system_sgpr_workgroup_id_x 1
  .amdhsa_float_denorm_mode_32 3
  .amdhsa_float_denorm_mode_16_64 3
.end_amdhsa_kernel
```
